```python
import torch

def _softmax(x, axis=-1):
    return torch.softmax(x, dim=axis)
def _gelu(x):
    return torch.nn.functional.gelu(x, approximate="tanh")
def _silu(x):
    return torch.nn.functional.silu(x)
def _sigmoid(x):
    return torch.sigmoid(x)
def _layernorm(x, axis=-1, eps=1e-5):
    m = x.mean(dim=axis, keepdim=True)
    v = x.var(dim=axis, keepdim=True, unbiased=False)
    return (x - m) / torch.sqrt(v + eps)
def _scatter_add(tgt, idx, src, axis=0):
    return tgt.clone().index_add_(axis, idx, src)
def _segment_sum(src, seg, n):
    out = torch.zeros((n,) + src.shape[1:], dtype=src.dtype)
    return out.index_add_(0, seg, src)
def _pad(x, pw):
    flat = tuple(v for pair in reversed(pw) for v in pair)
    return torch.nn.functional.pad(x, flat)

kernel_name = 'concat_heads__linear_kernel_hedgehog__ssm_conv_s4__prompt'

def setup_inputs():

    _w = (lambda a: (lambda t: t.to(torch.bfloat16) if t.is_floating_point() else t)(torch.as_tensor(a)))
    def _A_setup():
        B, S, D, H = 1, 2048, 512, 32
        Dh = D // H
        return {
            "x": _w((lambda *s: torch.randn(*s, dtype=torch.bfloat16) * 0.4)(B, S, D)),
            "wqkv": _w((lambda *s: torch.randn(*s, dtype=torch.bfloat16) * 0.4)(D, 3 * D)),
            "w_phi": _w((lambda *s: torch.randn(*s, dtype=torch.bfloat16) * 0.4)(H, Dh, Dh) * (Dh ** -0.5)),
            "wo": _w((lambda *s: torch.randn(*s, dtype=torch.bfloat16) * 0.05)(D, D)),
        }
    _A_in = _A_setup()

    def _B_setup():
        B, L, D, N = 1, 2048, 512, 128
        A_re = -(lambda _x: torch.exp(torch.as_tensor(_x)))((lambda *s: torch.randn(*s, dtype=torch.bfloat16) * 6.4)(D, N))
        A_im = torch.pi * (lambda *s: torch.randn(*s, dtype=torch.bfloat16) * 0.1)(D, N)
        B_re = (lambda *s: torch.randn(*s, dtype=torch.bfloat16) * 0.2)(D, N)
        B_im = (lambda *s: torch.randn(*s, dtype=torch.bfloat16) * 0.2)(D, N)
        C_re = (lambda *s: torch.randn(*s, dtype=torch.bfloat16) * 0.2)(D, N)
        C_im = (lambda *s: torch.randn(*s, dtype=torch.bfloat16) * 0.2)(D, N)
        log_dt = (lambda *s: torch.randn(*s, dtype=torch.bfloat16) * 0.1)(D) * 0.5 - 4.0
        Dskip = (lambda *s: torch.randn(*s, dtype=torch.bfloat16) * 0.1)(D)
        return {
            "u": _w((lambda *s: torch.randn(*s, dtype=torch.bfloat16) * 0.05)(B, L, D)),
            "A_re": _w(A_re),
            "A_im": _w(A_im),
            "B_re": _w(B_re),
            "B_im": _w(B_im),
            "C_re": _w(C_re),
            "C_im": _w(C_im),
            "log_dt": _w(log_dt),
            "Dskip": _w(Dskip),
        }
    _B_in = _B_setup()

    return {
        "A_x": _A_in["x"],
        "A_wqkv": _A_in["wqkv"],
        "A_w_phi": _A_in["w_phi"],
        "A_wo": _A_in["wo"],
        "B_u": _B_in["u"],
        "B_A_re": _B_in["A_re"],
        "B_A_im": _B_in["A_im"],
        "B_B_re": _B_in["B_re"],
        "B_B_im": _B_in["B_im"],
        "B_C_re": _B_in["C_re"],
        "B_C_im": _B_in["C_im"],
        "B_log_dt": _B_in["log_dt"],
        "B_Dskip": _B_in["Dskip"],
    }

def reference(A_x, A_wqkv, A_w_phi, A_wo, B_u, B_A_re, B_A_im, B_B_re, B_B_im, B_C_re, B_C_im, B_log_dt, B_Dskip):
    def _A_ref(x, wqkv, w_phi, wo):
        B, S, D = x.shape
        H = 32; Dh = D // H
        qkv = (lambda x, *d: x.permute(*d))((x @ wqkv).reshape(B, S, 3, H, Dh), 2, 0, 3, 1, 4)
        q, k, v = qkv[0], qkv[1], qkv[2]
        pq = torch.einsum("bhsd,hdf->bhsf", q, w_phi)
        pk = torch.einsum("bhsd,hdf->bhsf", k, w_phi)
        phi_q = torch.concatenate([_softmax(pq, axis=-1), _softmax(-pq, axis=-1)], axis=-1)
        phi_k = torch.concatenate([_softmax(pk, axis=-1), _softmax(-pk, axis=-1)], axis=-1)
        kv = torch.einsum("bhsf,bhsd->bhfd", phi_k, v)
        z  = torch.einsum("bhsf->bhf", phi_k)
        num = torch.einsum("bhqf,bhfd->bhqd", phi_q, kv)
        den = torch.einsum("bhqf,bhf->bhq", phi_q, z)[..., None] + 1e-6
        o = num / den
        return (lambda x, *d: x.permute(*d))(o, 0, 2, 1, 3).reshape(B, S, D) @ wo

    def _B_ref(u, A_re, A_im, B_re, B_im, C_re, C_im, log_dt, Dskip):
        Bsz, L, D = u.shape
        dt = torch.exp(log_dt)[:, None]
        A = A_re + 1j * A_im
        Bc = B_re + 1j * B_im
        Cc = C_re + 1j * C_im
        logdA = dt * A
        dB = dt * Bc
        l = (lambda x, dt: x.to(dt))(torch.arange(L), A_re.dtype)
        P = torch.exp(logdA[:, :, None] * l[None, None, :])
        K = torch.einsum("dn,dnl,dn->dl", Cc, P, dB).real
        L2 = 2 * L
        Kp = _pad(K, ((0, 0), (0, L)))
        up = (lambda x, *d: x.permute(*d))(u, 0, 2, 1)
        up = _pad(up, ((0, 0), (0, 0), (0, L)))
        Kf = (lambda x, axes=(-2,-1): torch.fft.rfft2(x.float(), dim=axes))(Kp[:, None, :], axes=(-2, -1))
        Uf = (lambda x, axes=(-2,-1): torch.fft.rfft2(x.float(), dim=axes))(up[:, :, None, :], axes=(-2, -1))
        Yf = Uf * Kf[None, :, :, :]
        y = (lambda x, s, axes=(-2,-1): torch.fft.irfft2(x, s=s, dim=axes).to(torch.bfloat16))(Yf, (1, L2), axes=(-2, -1))[:, :, 0, :L]
        y = (lambda x, *d: x.permute(*d))(y, 0, 2, 1) + u * Dskip[None, None, :]
        return y

    a = _A_ref(A_x, A_wqkv, A_w_phi, A_wo)
    b = _B_ref(B_u, B_A_re, B_A_im, B_B_re, B_B_im, B_C_re, B_C_im, B_log_dt, B_Dskip)
    return torch.concatenate([a, b], axis=-1)
```

```asm
; @launch grid=(256,1,1) block=(512,1,1) lds=160768
.amdgcn_target "amdgcn-amd-amdhsa--gfx950"
.text
.globl concat_heads__linear_kernel_hedgehog__ssm_conv_s4__prompt_kernel
.p2align 8
.type concat_heads__linear_kernel_hedgehog__ssm_conv_s4__prompt_kernel,@function
concat_heads__linear_kernel_hedgehog__ssm_conv_s4__prompt_kernel:
    s_cmp_ge_u32 s2, 256
    s_cbranch_scc1 L_end
    s_load_dwordx16 s[4:19], s[0:1], 0
    s_load_dwordx16 s[20:35], s[0:1], 64
    v_lshrrev_b32 v2, 6, v0
    s_nop 0
    v_readfirstlane_b32 s36, v2
    s_bfe_u32 s60, s2, 0x30003
    s_cmp_lg_u32 s60, s36
    s_cbranch_scc1 L_nopf
    s_getpc_b64 s[62:63]
L_pc:
    v_lshlrev_b32 v98, 6, v0
    v_min_u32 v98, L_end-L_pc, v98
    v_mov_b32 v99, s63
    v_add_co_u32 v98, vcc, s62, v98
    v_addc_co_u32 v99, vcc, 0, v99, vcc
    global_load_dword v100, v[98:99], off
L_nopf:
    v_lshrrev_b32 v2, 6, v0
    v_and_b32 v1, 63, v0
    v_readfirstlane_b32 s36, v2
    v_and_b32 v3, 15, v0
    v_lshlrev_b32 v3, 2, v3
    v_add_u32 v3, 160256, v3
    v_mov_b32 v4, 0
    ds_write_b32 v3, v4
    s_and_b32 s60, s2, 3
    s_lshl_b32 s60, s60, 2
    s_bfe_u32 s61, s2, 0x20003
    s_add_u32 s37, s60, s61
    s_bfe_u32 s60, s2, 0x10002
    s_lshl_b32 s60, s60, 3
    s_lshr_b32 s61, s2, 5
    s_add_u32 s38, s60, s61
    s_and_b32 s39, s36, 3
    s_waitcnt lgkmcnt(0)
    s_mov_b32 s40, s34
    s_mov_b32 s41, s35
    s_mov_b32 s42, 0x1000000
    s_mov_b32 s43, 0x00020000
    s_cmp_ge_u32 s36, 4
    s_cbranch_scc1 L_roleB
    s_lshl_b32 s60, s38, 6
    s_sub_u32 s61, 1572864, s60
    s_add_u32 s48, s6, s60
    s_addc_u32 s49, s7, 0
    s_mov_b32 s50, s61
    s_mov_b32 s51, 0x00020000
    v_lshrrev_b32 v18, 2, v1
    v_and_b32 v19, 3, v1
    s_movk_i32 s60, 3072
    v_mul_lo_u32 v3, v18, s60
    v_lshl_add_u32 v3, v19, 4, v3
    s_mul_i32 s66, s39, 49152
    s_add_u32 s76, s66, 1024
    s_add_u32 s77, s66, 2048
    s_lshl_b32 s67, s39, 10
    s_lshl_b32 s63, s37, 1
    s_add_u32 s63, s63, s38
    s_barrier
    s_add_u32 s64, s63, 0
    s_and_b32 s64, s64, 7
    s_mul_i32 s65, s64, 196608
    s_add_u32 s65, s65, s76
    s_add_u32 m0, s67, 0
    s_nop 0
    buffer_load_dwordx4 v3, s[48:51], s65 offen lds
    s_add_u32 s64, s63, 0
    s_and_b32 s64, s64, 7
    s_mul_i32 s65, s64, 196608
    s_add_u32 s65, s65, s77
    s_add_u32 m0, s67, 32768
    s_nop 0
    buffer_load_dwordx4 v3, s[48:51], s65 offen lds
    s_lshl_b32 s60, s37, 17
    s_lshl_b32 s61, s39, 15
    s_add_u32 s60, s60, s61
    s_add_u32 s44, s4, s60
    s_addc_u32 s45, s5, 0
    s_mov_b32 s46, 0x8000
    s_mov_b32 s47, 0x00020000
    v_lshrrev_b32 v23, 5, v1
    v_and_b32 v56, 28, v1
    v_lshlrev_b32 v56, 10, v56
    v_lshl_add_u32 v56, v23, 6, v56
    v_lshl_add_u32 v56, v19, 4, v56
    v_xor_b32 v57, 16, v56
    v_xor_b32 v58, 32, v56
    v_xor_b32 v59, 48, v56
    s_lshl_b32 s60, s38, 10
    s_add_u32 s52, s8, s60
    s_addc_u32 s53, s9, 0
    s_mov_b32 s54, 0x400
    s_mov_b32 s55, 0x00020000
    v_lshlrev_b32 v15, 4, v1
    s_add_u32 s68, s63, 0
    s_and_b32 s68, s68, 7
    s_lshl_b32 s68, s68, 7
    buffer_load_dwordx4 v[128:131], v56, s[44:47], s68 offen offset:0
    buffer_load_dwordx4 v[132:135], v57, s[44:47], s68 offen offset:1024
    buffer_load_dwordx4 v[136:139], v58, s[44:47], s68 offen offset:2048
    buffer_load_dwordx4 v[140:143], v59, s[44:47], s68 offen offset:3072
    s_add_u32 s64, s63, 1
    s_and_b32 s64, s64, 7
    s_mul_i32 s65, s64, 196608
    s_add_u32 s65, s65, s76
    s_add_u32 m0, s67, 4096
    s_nop 0
    buffer_load_dwordx4 v3, s[48:51], s65 offen lds
    s_add_u32 s64, s63, 1
    s_and_b32 s64, s64, 7
    s_mul_i32 s65, s64, 196608
    s_add_u32 s65, s65, s77
    s_add_u32 m0, s67, 36864
    s_nop 0
    buffer_load_dwordx4 v3, s[48:51], s65 offen lds
    s_add_u32 s68, s63, 1
    s_and_b32 s68, s68, 7
    s_lshl_b32 s68, s68, 7
    buffer_load_dwordx4 v[144:147], v56, s[44:47], s68 offen offset:0
    buffer_load_dwordx4 v[148:151], v57, s[44:47], s68 offen offset:1024
    buffer_load_dwordx4 v[152:155], v58, s[44:47], s68 offen offset:2048
    buffer_load_dwordx4 v[156:159], v59, s[44:47], s68 offen offset:3072
    s_add_u32 s64, s63, 2
    s_and_b32 s64, s64, 7
    s_mul_i32 s65, s64, 196608
    s_add_u32 s65, s65, s76
    s_add_u32 m0, s67, 8192
    s_nop 0
    buffer_load_dwordx4 v3, s[48:51], s65 offen lds
    s_add_u32 s64, s63, 2
    s_and_b32 s64, s64, 7
    s_mul_i32 s65, s64, 196608
    s_add_u32 s65, s65, s77
    s_add_u32 m0, s67, 40960
    s_nop 0
    buffer_load_dwordx4 v3, s[48:51], s65 offen lds
    s_add_u32 s64, s63, 3
    s_and_b32 s64, s64, 7
    s_mul_i32 s65, s64, 196608
    s_add_u32 s65, s65, s76
    s_add_u32 m0, s67, 12288
    s_nop 0
    buffer_load_dwordx4 v3, s[48:51], s65 offen lds
    s_add_u32 s64, s63, 3
    s_and_b32 s64, s64, 7
    s_mul_i32 s65, s64, 196608
    s_add_u32 s65, s65, s77
    s_add_u32 m0, s67, 45056
    s_nop 0
    buffer_load_dwordx4 v3, s[48:51], s65 offen lds
    v_lshrrev_b32 v20, 4, v1
    v_bfe_u32 v25, v1, 2, 2
    v_lshl_add_u32 v26, v23, 5, v25
    v_and_b32 v27, 1, v20
    v_lshlrev_b32 v4, 6, v26
    v_lshl_add_u32 v4, v27, 5, v4
    v_lshl_add_u32 v4, v19, 3, v4
    v_add_u32 v5, 0x10000, v4
    v_mov_b32 v6, 160256
    s_lshl_b32 s60, s39, 2
    s_add_u32 s60, s60, 160256
    v_mov_b32 v7, s60
    s_mov_b32 s62, 0x3fb8aa3b
    s_mov_b32 s70, 0xaaaaaaaa
    s_mov_b32 s71, 0xaaaaaaaa
    s_mov_b32 s72, 0xcccccccc
    s_mov_b32 s73, 0xcccccccc
    v_lshl_add_u32 v62, v23, 2, v25
    v_lshlrev_b32 v62, 5, v62
    v_lshl_add_u32 v62, v27, 9, v62
    v_lshl_add_u32 v62, v19, 3, v62
    v_add_u32 v62, 159232, v62
    v_cmp_eq_u32 s[74:75], 0, v27
    v_and_b32 v60, 31, v1
    v_lshlrev_b32 v60, 5, v60
    v_lshl_add_u32 v60, v23, 4, v60
    s_lshl_b32 s60, s39, 12
    s_add_u32 s60, s60, 98304
    v_add_u32 v61, s60, v60
    v_add_u32 v60, s67, v60
    s_waitcnt vmcnt(8)
    v_mov_b32 v12, 1
    s_mov_b64 exec, 1
    ds_write_b32 v7, v12
    s_mov_b64 exec, -1
    s_mov_b32 s79, 0
L_w_1:
    ds_read_b128 v[8:11], v6 offset:0
    s_waitcnt lgkmcnt(0)
    v_min3_u32 v8, v8, v9, v10
    v_min_u32 v8, v8, v11
    s_nop 0
    v_readfirstlane_b32 s78, v8
    s_nop 0
    s_cmp_ge_u32 s78, 1
    s_cbranch_scc1 L_wd_2
    s_add_u32 s79, s79, 1
    s_cmp_lt_u32 s79, 200000
    s_cbranch_scc1 L_w_1
L_wd_2:
    ds_read_b64_tr_b16 v[104:105], v4 offset:0
    ds_read_b64_tr_b16 v[106:107], v4 offset:256
    ds_read_b64_tr_b16 v[108:109], v4 offset:512
    ds_read_b64_tr_b16 v[110:111], v4 offset:768
    ds_read_b64_tr_b16 v[112:113], v4 offset:1024
    ds_read_b64_tr_b16 v[114:115], v4 offset:1280
    ds_read_b64_tr_b16 v[116:117], v4 offset:1536
    ds_read_b64_tr_b16 v[118:119], v4 offset:1792
    s_waitcnt vmcnt(10)
    v_cndmask_b32 v36, v132, v128, s[70:71]
    v_cndmask_b32 v37, v133, v129, s[70:71]
    v_cndmask_b32 v38, v134, v130, s[70:71]
    v_cndmask_b32 v39, v135, v131, s[70:71]
    v_cndmask_b32 v40, v136, v140, s[70:71]
    v_cndmask_b32 v41, v137, v141, s[70:71]
    v_cndmask_b32 v42, v138, v142, s[70:71]
    v_cndmask_b32 v43, v139, v143, s[70:71]
    v_cndmask_b32 v44, v140, v136, s[70:71]
    v_cndmask_b32 v45, v141, v137, s[70:71]
    v_cndmask_b32 v46, v142, v138, s[70:71]
    v_cndmask_b32 v47, v143, v139, s[70:71]
    v_cndmask_b32 v32, v128, v132, s[70:71]
    v_cndmask_b32 v33, v129, v133, s[70:71]
    v_cndmask_b32 v34, v130, v134, s[70:71]
    v_cndmask_b32 v35, v131, v135, s[70:71]
    v_cndmask_b32 v132, v36, v44, s[72:73]
    v_cndmask_b32 v133, v37, v45, s[72:73]
    v_cndmask_b32 v134, v38, v46, s[72:73]
    v_cndmask_b32 v135, v39, v47, s[72:73]
    v_cndmask_b32 v136, v40, v32, s[72:73]
    v_cndmask_b32 v137, v41, v33, s[72:73]
    v_cndmask_b32 v138, v42, v34, s[72:73]
    v_cndmask_b32 v139, v43, v35, s[72:73]
    v_cndmask_b32 v140, v44, v36, s[72:73]
    v_cndmask_b32 v141, v45, v37, s[72:73]
    v_cndmask_b32 v142, v46, v38, s[72:73]
    v_cndmask_b32 v143, v47, v39, s[72:73]
    v_cndmask_b32 v128, v32, v40, s[72:73]
    v_cndmask_b32 v129, v33, v41, s[72:73]
    v_cndmask_b32 v130, v34, v42, s[72:73]
    v_cndmask_b32 v131, v35, v43, s[72:73]
    v_mov_b32_dpp v132, v132 quad_perm:[1,0,3,2] row_mask:0xf bank_mask:0xf
    v_mov_b32_dpp v133, v133 quad_perm:[1,0,3,2] row_mask:0xf bank_mask:0xf
    v_mov_b32_dpp v134, v134 quad_perm:[1,0,3,2] row_mask:0xf bank_mask:0xf
    v_mov_b32_dpp v135, v135 quad_perm:[1,0,3,2] row_mask:0xf bank_mask:0xf
    v_mov_b32_dpp v136, v136 quad_perm:[2,3,0,1] row_mask:0xf bank_mask:0xf
    v_mov_b32_dpp v137, v137 quad_perm:[2,3,0,1] row_mask:0xf bank_mask:0xf
    v_mov_b32_dpp v138, v138 quad_perm:[2,3,0,1] row_mask:0xf bank_mask:0xf
    v_mov_b32_dpp v139, v139 quad_perm:[2,3,0,1] row_mask:0xf bank_mask:0xf
    v_mov_b32_dpp v140, v140 quad_perm:[3,2,1,0] row_mask:0xf bank_mask:0xf
    v_mov_b32_dpp v141, v141 quad_perm:[3,2,1,0] row_mask:0xf bank_mask:0xf
    v_mov_b32_dpp v142, v142 quad_perm:[3,2,1,0] row_mask:0xf bank_mask:0xf
    v_mov_b32_dpp v143, v143 quad_perm:[3,2,1,0] row_mask:0xf bank_mask:0xf
    s_waitcnt lgkmcnt(6)
    v_mfma_f32_32x32x16_bf16 v[64:79], v[104:107], v[128:131], 0
    ds_read_b64_tr_b16 v[120:121], v4 offset:32768
    ds_read_b64_tr_b16 v[122:123], v4 offset:33024
    s_add_u32 s68, s63, 2
    s_and_b32 s68, s68, 7
    s_lshl_b32 s68, s68, 7
    buffer_load_dwordx4 v[160:163], v56, s[44:47], s68 offen offset:0
    s_waitcnt lgkmcnt(6)
    v_mfma_f32_32x32x16_bf16 v[64:79], v[108:111], v[132:135], v[64:79]
    ds_read_b64_tr_b16 v[124:125], v4 offset:33280
    ds_read_b64_tr_b16 v[126:127], v4 offset:33536
    buffer_load_dwordx4 v[164:167], v57, s[44:47], s68 offen offset:1024
    s_waitcnt lgkmcnt(6)
    v_mfma_f32_32x32x16_bf16 v[64:79], v[112:115], v[136:139], v[64:79]
    ds_read_b64_tr_b16 v[104:105], v4 offset:33792
    ds_read_b64_tr_b16 v[106:107], v4 offset:34048
    buffer_load_dwordx4 v[168:171], v58, s[44:47], s68 offen offset:2048
    s_waitcnt lgkmcnt(6)
    v_mfma_f32_32x32x16_bf16 v[64:79], v[116:119], v[140:143], v[64:79]
    ds_read_b64_tr_b16 v[108:109], v4 offset:34304
    ds_read_b64_tr_b16 v[110:111], v4 offset:34560
    buffer_load_dwordx4 v[172:175], v59, s[44:47], s68 offen offset:3072
    s_waitcnt lgkmcnt(6)
    v_mfma_f32_32x32x16_bf16 v[80:95], v[120:123], v[128:131], 0
    ds_read_b64_tr_b16 v[112:113], v4 offset:4096
    ds_read_b64_tr_b16 v[114:115], v4 offset:4352
    s_waitcnt vmcnt(8)
    v_cndmask_b32 v36, v148, v144, s[70:71]
    v_cndmask_b32 v37, v149, v145, s[70:71]
    v_cndmask_b32 v38, v150, v146, s[70:71]
    v_cndmask_b32 v39, v151, v147, s[70:71]
    v_cndmask_b32 v40, v152, v156, s[70:71]
    v_cndmask_b32 v41, v153, v157, s[70:71]
    v_cndmask_b32 v42, v154, v158, s[70:71]
    v_cndmask_b32 v43, v155, v159, s[70:71]
    v_cndmask_b32 v44, v156, v152, s[70:71]
    v_cndmask_b32 v45, v157, v153, s[70:71]
    v_cndmask_b32 v46, v158, v154, s[70:71]
    s_add_u32 s68, s63, 3
    s_and_b32 s68, s68, 7
    s_lshl_b32 s68, s68, 7
    buffer_load_dwordx4 v[176:179], v56, s[44:47], s68 offen offset:0
    s_waitcnt lgkmcnt(6)
    v_mfma_f32_32x32x16_bf16 v[80:95], v[124:127], v[132:135], v[80:95]
    ds_read_b64_tr_b16 v[116:117], v4 offset:4608
    ds_read_b64_tr_b16 v[118:119], v4 offset:4864
    v_cndmask_b32 v47, v159, v155, s[70:71]
    v_cndmask_b32 v32, v144, v148, s[70:71]
    v_cndmask_b32 v33, v145, v149, s[70:71]
    v_cndmask_b32 v34, v146, v150, s[70:71]
    v_cndmask_b32 v35, v147, v151, s[70:71]
    v_cndmask_b32 v148, v36, v44, s[72:73]
    v_cndmask_b32 v149, v37, v45, s[72:73]
    v_cndmask_b32 v150, v38, v46, s[72:73]
    v_cndmask_b32 v151, v39, v47, s[72:73]
    v_cndmask_b32 v152, v40, v32, s[72:73]
    v_cndmask_b32 v153, v41, v33, s[72:73]
    buffer_load_dwordx4 v[180:183], v57, s[44:47], s68 offen offset:1024
    s_waitcnt lgkmcnt(6)
    v_mfma_f32_32x32x16_bf16 v[80:95], v[104:107], v[136:139], v[80:95]
    ds_read_b64_tr_b16 v[120:121], v4 offset:5120
    ds_read_b64_tr_b16 v[122:123], v4 offset:5376
    v_cndmask_b32 v154, v42, v34, s[72:73]
    v_cndmask_b32 v155, v43, v35, s[72:73]
    v_cndmask_b32 v156, v44, v36, s[72:73]
    v_cndmask_b32 v157, v45, v37, s[72:73]
    v_cndmask_b32 v158, v46, v38, s[72:73]
    v_cndmask_b32 v159, v47, v39, s[72:73]
    v_cndmask_b32 v144, v32, v40, s[72:73]
    v_cndmask_b32 v145, v33, v41, s[72:73]
    v_cndmask_b32 v146, v34, v42, s[72:73]
    v_cndmask_b32 v147, v35, v43, s[72:73]
    v_mov_b32_dpp v148, v148 quad_perm:[1,0,3,2] row_mask:0xf bank_mask:0xf
    buffer_load_dwordx4 v[184:187], v58, s[44:47], s68 offen offset:2048
    s_waitcnt lgkmcnt(6)
    v_mfma_f32_32x32x16_bf16 v[80:95], v[108:111], v[140:143], v[80:95]
    ds_read_b64_tr_b16 v[124:125], v4 offset:5632
    ds_read_b64_tr_b16 v[126:127], v4 offset:5888
    v_mov_b32_dpp v149, v149 quad_perm:[1,0,3,2] row_mask:0xf bank_mask:0xf
    v_mov_b32_dpp v150, v150 quad_perm:[1,0,3,2] row_mask:0xf bank_mask:0xf
    v_mov_b32_dpp v151, v151 quad_perm:[1,0,3,2] row_mask:0xf bank_mask:0xf
    v_mov_b32_dpp v152, v152 quad_perm:[2,3,0,1] row_mask:0xf bank_mask:0xf
    v_mov_b32_dpp v153, v153 quad_perm:[2,3,0,1] row_mask:0xf bank_mask:0xf
    v_mov_b32_dpp v154, v154 quad_perm:[2,3,0,1] row_mask:0xf bank_mask:0xf
    v_mov_b32_dpp v155, v155 quad_perm:[2,3,0,1] row_mask:0xf bank_mask:0xf
    v_mov_b32_dpp v156, v156 quad_perm:[3,2,1,0] row_mask:0xf bank_mask:0xf
    v_mov_b32_dpp v157, v157 quad_perm:[3,2,1,0] row_mask:0xf bank_mask:0xf
    v_mov_b32_dpp v158, v158 quad_perm:[3,2,1,0] row_mask:0xf bank_mask:0xf
    v_mov_b32_dpp v159, v159 quad_perm:[3,2,1,0] row_mask:0xf bank_mask:0xf
    buffer_load_dwordx4 v[188:191], v59, s[44:47], s68 offen offset:3072
    s_waitcnt vmcnt(8)
    v_mov_b32 v12, 2
    s_mov_b64 exec, 1
    ds_write_b32 v7, v12
    s_mov_b64 exec, -1
    s_waitcnt lgkmcnt(7)
    v_mfma_f32_32x32x16_bf16 v[64:79], v[112:115], v[144:147], v[64:79]
    ds_read_b64_tr_b16 v[104:105], v4 offset:36864
    ds_read_b64_tr_b16 v[106:107], v4 offset:37120
    s_add_u32 s64, s63, 4
    s_and_b32 s64, s64, 7
    s_mul_i32 s65, s64, 196608
    s_add_u32 s65, s65, s76
    s_add_u32 m0, s67, 16384
    s_nop 0
    buffer_load_dwordx4 v3, s[48:51], s65 offen lds
    s_waitcnt lgkmcnt(7)
    v_mfma_f32_32x32x16_bf16 v[64:79], v[116:119], v[148:151], v[64:79]
    ds_read_b64_tr_b16 v[108:109], v4 offset:37376
    ds_read_b64_tr_b16 v[110:111], v4 offset:37632
    s_add_u32 s64, s63, 4
    s_and_b32 s64, s64, 7
    s_mul_i32 s65, s64, 196608
    s_add_u32 s65, s65, s77
    s_add_u32 m0, s67, 49152
    s_nop 0
    buffer_load_dwordx4 v3, s[48:51], s65 offen lds
    s_waitcnt lgkmcnt(7)
    v_mfma_f32_32x32x16_bf16 v[64:79], v[120:123], v[152:155], v[64:79]
    ds_read_b64_tr_b16 v[112:113], v4 offset:37888
    ds_read_b64_tr_b16 v[114:115], v4 offset:38144
    s_add_u32 s64, s63, 5
    s_and_b32 s64, s64, 7
    s_mul_i32 s65, s64, 196608
    s_add_u32 s65, s65, s76
    s_add_u32 m0, s67, 20480
    s_nop 0
    buffer_load_dwordx4 v3, s[48:51], s65 offen lds
    s_waitcnt lgkmcnt(7)
    v_mfma_f32_32x32x16_bf16 v[64:79], v[124:127], v[156:159], v[64:79]
    ds_read_b64_tr_b16 v[116:117], v4 offset:38400
    ds_read_b64_tr_b16 v[118:119], v4 offset:38656
    ds_read_b128 v[8:11], v6 offset:0
    s_add_u32 s64, s63, 5
    s_and_b32 s64, s64, 7
    s_mul_i32 s65, s64, 196608
    s_add_u32 s65, s65, s77
    s_add_u32 m0, s67, 53248
    s_nop 0
    buffer_load_dwordx4 v3, s[48:51], s65 offen lds
    s_waitcnt lgkmcnt(7)
    v_mfma_f32_32x32x16_bf16 v[80:95], v[104:107], v[144:147], v[80:95]
    s_waitcnt lgkmcnt(0)
    v_min3_u32 v8, v8, v9, v10
    v_min_u32 v8, v8, v11
    s_nop 0
    v_readfirstlane_b32 s78, v8
    s_nop 0
    s_cmp_ge_u32 s78, 2
    s_cbranch_scc1 L_wd_4
    s_mov_b32 s79, 0
L_w_3:
    ds_read_b128 v[8:11], v6 offset:0
    s_waitcnt lgkmcnt(0)
    v_min3_u32 v8, v8, v9, v10
    v_min_u32 v8, v8, v11
    s_nop 0
    v_readfirstlane_b32 s78, v8
    s_nop 0
    s_cmp_ge_u32 s78, 2
    s_cbranch_scc1 L_wd_4
    s_add_u32 s79, s79, 1
    s_cmp_lt_u32 s79, 200000
    s_cbranch_scc1 L_w_3
L_wd_4:
    ds_read_b64_tr_b16 v[120:121], v4 offset:8192
    ds_read_b64_tr_b16 v[122:123], v4 offset:8448
    s_waitcnt vmcnt(8)
    v_cndmask_b32 v36, v164, v160, s[70:71]
    v_cndmask_b32 v37, v165, v161, s[70:71]
    v_cndmask_b32 v38, v166, v162, s[70:71]
    v_cndmask_b32 v39, v167, v163, s[70:71]
    v_cndmask_b32 v40, v168, v172, s[70:71]
    v_cndmask_b32 v41, v169, v173, s[70:71]
    v_cndmask_b32 v42, v170, v174, s[70:71]
    v_cndmask_b32 v43, v171, v175, s[70:71]
    v_cndmask_b32 v44, v172, v168, s[70:71]
    v_cndmask_b32 v45, v173, v169, s[70:71]
    v_cndmask_b32 v46, v174, v170, s[70:71]
    s_add_u32 s68, s63, 4
    s_and_b32 s68, s68, 7
    s_lshl_b32 s68, s68, 7
    buffer_load_dwordx4 v[192:195], v56, s[44:47], s68 offen offset:0
    s_waitcnt lgkmcnt(7)
    v_mfma_f32_32x32x16_bf16 v[80:95], v[108:111], v[148:151], v[80:95]
    ds_read_b64_tr_b16 v[124:125], v4 offset:8704
    ds_read_b64_tr_b16 v[126:127], v4 offset:8960
    v_cndmask_b32 v47, v175, v171, s[70:71]
    v_cndmask_b32 v32, v160, v164, s[70:71]
    v_cndmask_b32 v33, v161, v165, s[70:71]
    v_cndmask_b32 v34, v162, v166, s[70:71]
    v_cndmask_b32 v35, v163, v167, s[70:71]
    v_cndmask_b32 v164, v36, v44, s[72:73]
    v_cndmask_b32 v165, v37, v45, s[72:73]
    v_cndmask_b32 v166, v38, v46, s[72:73]
    v_cndmask_b32 v167, v39, v47, s[72:73]
    v_cndmask_b32 v168, v40, v32, s[72:73]
    v_cndmask_b32 v169, v41, v33, s[72:73]
    buffer_load_dwordx4 v[196:199], v57, s[44:47], s68 offen offset:1024
    s_waitcnt lgkmcnt(7)
    v_mfma_f32_32x32x16_bf16 v[80:95], v[112:115], v[152:155], v[80:95]
    ds_read_b64_tr_b16 v[104:105], v4 offset:9216
    ds_read_b64_tr_b16 v[106:107], v4 offset:9472
    v_cndmask_b32 v170, v42, v34, s[72:73]
    v_cndmask_b32 v171, v43, v35, s[72:73]
    v_cndmask_b32 v172, v44, v36, s[72:73]
    v_cndmask_b32 v173, v45, v37, s[72:73]
    v_cndmask_b32 v174, v46, v38, s[72:73]
    v_cndmask_b32 v175, v47, v39, s[72:73]
    v_cndmask_b32 v160, v32, v40, s[72:73]
    v_cndmask_b32 v161, v33, v41, s[72:73]
    v_cndmask_b32 v162, v34, v42, s[72:73]
    v_cndmask_b32 v163, v35, v43, s[72:73]
    v_mov_b32_dpp v164, v164 quad_perm:[1,0,3,2] row_mask:0xf bank_mask:0xf
    buffer_load_dwordx4 v[200:203], v58, s[44:47], s68 offen offset:2048
    s_waitcnt lgkmcnt(7)
    v_mfma_f32_32x32x16_bf16 v[80:95], v[116:119], v[156:159], v[80:95]
    ds_read_b64_tr_b16 v[108:109], v4 offset:9728
    ds_read_b64_tr_b16 v[110:111], v4 offset:9984
    v_mov_b32_dpp v165, v165 quad_perm:[1,0,3,2] row_mask:0xf bank_mask:0xf
    v_mov_b32_dpp v166, v166 quad_perm:[1,0,3,2] row_mask:0xf bank_mask:0xf
    v_mov_b32_dpp v167, v167 quad_perm:[1,0,3,2] row_mask:0xf bank_mask:0xf
    v_mov_b32_dpp v168, v168 quad_perm:[2,3,0,1] row_mask:0xf bank_mask:0xf
    v_mov_b32_dpp v169, v169 quad_perm:[2,3,0,1] row_mask:0xf bank_mask:0xf
    v_mov_b32_dpp v170, v170 quad_perm:[2,3,0,1] row_mask:0xf bank_mask:0xf
    v_mov_b32_dpp v171, v171 quad_perm:[2,3,0,1] row_mask:0xf bank_mask:0xf
    v_mov_b32_dpp v172, v172 quad_perm:[3,2,1,0] row_mask:0xf bank_mask:0xf
    v_mov_b32_dpp v173, v173 quad_perm:[3,2,1,0] row_mask:0xf bank_mask:0xf
    v_mov_b32_dpp v174, v174 quad_perm:[3,2,1,0] row_mask:0xf bank_mask:0xf
    v_mov_b32_dpp v175, v175 quad_perm:[3,2,1,0] row_mask:0xf bank_mask:0xf
    buffer_load_dwordx4 v[204:207], v59, s[44:47], s68 offen offset:3072
    s_waitcnt lgkmcnt(6)
    v_mfma_f32_32x32x16_bf16 v[64:79], v[120:123], v[160:163], v[64:79]
    ds_read_b64_tr_b16 v[112:113], v4 offset:40960
    ds_read_b64_tr_b16 v[114:115], v4 offset:41216
    s_add_u32 s68, s63, 5
    s_and_b32 s68, s68, 7
    s_lshl_b32 s68, s68, 7
    buffer_load_dwordx4 v[208:211], v56, s[44:47], s68 offen offset:0
    s_waitcnt lgkmcnt(6)
    v_mfma_f32_32x32x16_bf16 v[64:79], v[124:127], v[164:167], v[64:79]
    ds_read_b64_tr_b16 v[116:117], v4 offset:41472
    ds_read_b64_tr_b16 v[118:119], v4 offset:41728
    buffer_load_dwordx4 v[212:215], v57, s[44:47], s68 offen offset:1024
    s_waitcnt lgkmcnt(6)
    v_mfma_f32_32x32x16_bf16 v[64:79], v[104:107], v[168:171], v[64:79]
    ds_read_b64_tr_b16 v[120:121], v4 offset:41984
    ds_read_b64_tr_b16 v[122:123], v4 offset:42240
    buffer_load_dwordx4 v[216:219], v58, s[44:47], s68 offen offset:2048
    s_waitcnt lgkmcnt(6)
    v_mfma_f32_32x32x16_bf16 v[64:79], v[108:111], v[172:175], v[64:79]
    ds_read_b64_tr_b16 v[124:125], v4 offset:42496
    ds_read_b64_tr_b16 v[126:127], v4 offset:42752
    buffer_load_dwordx4 v[220:223], v59, s[44:47], s68 offen offset:3072
    s_waitcnt lgkmcnt(6)
    v_mfma_f32_32x32x16_bf16 v[80:95], v[112:115], v[160:163], v[80:95]
    ds_read_b64_tr_b16 v[104:105], v4 offset:12288
    ds_read_b64_tr_b16 v[106:107], v4 offset:12544
    s_waitcnt vmcnt(12)
    v_cndmask_b32 v36, v180, v176, s[70:71]
    v_cndmask_b32 v37, v181, v177, s[70:71]
    v_cndmask_b32 v38, v182, v178, s[70:71]
    v_cndmask_b32 v39, v183, v179, s[70:71]
    v_cndmask_b32 v40, v184, v188, s[70:71]
    v_cndmask_b32 v41, v185, v189, s[70:71]
    v_cndmask_b32 v42, v186, v190, s[70:71]
    v_cndmask_b32 v43, v187, v191, s[70:71]
    v_cndmask_b32 v44, v188, v184, s[70:71]
    v_cndmask_b32 v45, v189, v185, s[70:71]
    v_cndmask_b32 v46, v190, v186, s[70:71]
    s_add_u32 s64, s63, 6
    s_and_b32 s64, s64, 7
    s_mul_i32 s65, s64, 196608
    s_add_u32 s65, s65, s76
    s_add_u32 m0, s67, 24576
    s_nop 0
    buffer_load_dwordx4 v3, s[48:51], s65 offen lds
    s_waitcnt lgkmcnt(6)
    v_mfma_f32_32x32x16_bf16 v[80:95], v[116:119], v[164:167], v[80:95]
    ds_read_b64_tr_b16 v[108:109], v4 offset:12800
    ds_read_b64_tr_b16 v[110:111], v4 offset:13056
    v_cndmask_b32 v47, v191, v187, s[70:71]
    v_cndmask_b32 v32, v176, v180, s[70:71]
    v_cndmask_b32 v33, v177, v181, s[70:71]
    v_cndmask_b32 v34, v178, v182, s[70:71]
    v_cndmask_b32 v35, v179, v183, s[70:71]
    v_cndmask_b32 v180, v36, v44, s[72:73]
    v_cndmask_b32 v181, v37, v45, s[72:73]
    v_cndmask_b32 v182, v38, v46, s[72:73]
    v_cndmask_b32 v183, v39, v47, s[72:73]
    v_cndmask_b32 v184, v40, v32, s[72:73]
    v_cndmask_b32 v185, v41, v33, s[72:73]
    s_add_u32 s64, s63, 6
    s_and_b32 s64, s64, 7
    s_mul_i32 s65, s64, 196608
    s_add_u32 s65, s65, s77
    s_add_u32 m0, s67, 57344
    s_nop 0
    buffer_load_dwordx4 v3, s[48:51], s65 offen lds
    s_waitcnt lgkmcnt(6)
    v_mfma_f32_32x32x16_bf16 v[80:95], v[120:123], v[168:171], v[80:95]
    ds_read_b64_tr_b16 v[112:113], v4 offset:13312
    ds_read_b64_tr_b16 v[114:115], v4 offset:13568
    v_cndmask_b32 v186, v42, v34, s[72:73]
    v_cndmask_b32 v187, v43, v35, s[72:73]
    v_cndmask_b32 v188, v44, v36, s[72:73]
    v_cndmask_b32 v189, v45, v37, s[72:73]
    v_cndmask_b32 v190, v46, v38, s[72:73]
    v_cndmask_b32 v191, v47, v39, s[72:73]
    v_cndmask_b32 v176, v32, v40, s[72:73]
    v_cndmask_b32 v177, v33, v41, s[72:73]
    v_cndmask_b32 v178, v34, v42, s[72:73]
    v_cndmask_b32 v179, v35, v43, s[72:73]
    v_mov_b32_dpp v180, v180 quad_perm:[1,0,3,2] row_mask:0xf bank_mask:0xf
    s_add_u32 s64, s63, 7
    s_and_b32 s64, s64, 7
    s_mul_i32 s65, s64, 196608
    s_add_u32 s65, s65, s76
    s_add_u32 m0, s67, 28672
    s_nop 0
    buffer_load_dwordx4 v3, s[48:51], s65 offen lds
    s_waitcnt lgkmcnt(6)
    v_mfma_f32_32x32x16_bf16 v[80:95], v[124:127], v[172:175], v[80:95]
    ds_read_b64_tr_b16 v[116:117], v4 offset:13824
    ds_read_b64_tr_b16 v[118:119], v4 offset:14080
    v_mov_b32_dpp v181, v181 quad_perm:[1,0,3,2] row_mask:0xf bank_mask:0xf
    v_mov_b32_dpp v182, v182 quad_perm:[1,0,3,2] row_mask:0xf bank_mask:0xf
    v_mov_b32_dpp v183, v183 quad_perm:[1,0,3,2] row_mask:0xf bank_mask:0xf
    v_mov_b32_dpp v184, v184 quad_perm:[2,3,0,1] row_mask:0xf bank_mask:0xf
    v_mov_b32_dpp v185, v185 quad_perm:[2,3,0,1] row_mask:0xf bank_mask:0xf
    v_mov_b32_dpp v186, v186 quad_perm:[2,3,0,1] row_mask:0xf bank_mask:0xf
    v_mov_b32_dpp v187, v187 quad_perm:[2,3,0,1] row_mask:0xf bank_mask:0xf
    v_mov_b32_dpp v188, v188 quad_perm:[3,2,1,0] row_mask:0xf bank_mask:0xf
    v_mov_b32_dpp v189, v189 quad_perm:[3,2,1,0] row_mask:0xf bank_mask:0xf
    v_mov_b32_dpp v190, v190 quad_perm:[3,2,1,0] row_mask:0xf bank_mask:0xf
    v_mov_b32_dpp v191, v191 quad_perm:[3,2,1,0] row_mask:0xf bank_mask:0xf
    s_add_u32 s64, s63, 7
    s_and_b32 s64, s64, 7
    s_mul_i32 s65, s64, 196608
    s_add_u32 s65, s65, s77
    s_add_u32 m0, s67, 61440
    s_nop 0
    buffer_load_dwordx4 v3, s[48:51], s65 offen lds
    s_waitcnt vmcnt(12)
    v_mov_b32 v12, 3
    s_mov_b64 exec, 1
    ds_write_b32 v7, v12
    s_mov_b64 exec, -1
    s_waitcnt lgkmcnt(7)
    v_mfma_f32_32x32x16_bf16 v[64:79], v[104:107], v[176:179], v[64:79]
    ds_read_b64_tr_b16 v[120:121], v4 offset:45056
    ds_read_b64_tr_b16 v[122:123], v4 offset:45312
    s_add_u32 s68, s63, 6
    s_and_b32 s68, s68, 7
    s_lshl_b32 s68, s68, 7
    buffer_load_dwordx4 v[224:227], v56, s[44:47], s68 offen offset:0
    s_waitcnt lgkmcnt(7)
    v_mfma_f32_32x32x16_bf16 v[64:79], v[108:111], v[180:183], v[64:79]
    ds_read_b64_tr_b16 v[124:125], v4 offset:45568
    ds_read_b64_tr_b16 v[126:127], v4 offset:45824
    buffer_load_dwordx4 v[228:231], v57, s[44:47], s68 offen offset:1024
    s_waitcnt lgkmcnt(7)
    v_mfma_f32_32x32x16_bf16 v[64:79], v[112:115], v[184:187], v[64:79]
    ds_read_b64_tr_b16 v[104:105], v4 offset:46080
    ds_read_b64_tr_b16 v[106:107], v4 offset:46336
    buffer_load_dwordx4 v[232:235], v58, s[44:47], s68 offen offset:2048
    s_waitcnt lgkmcnt(7)
    v_mfma_f32_32x32x16_bf16 v[64:79], v[116:119], v[188:191], v[64:79]
    ds_read_b64_tr_b16 v[108:109], v4 offset:46592
    ds_read_b64_tr_b16 v[110:111], v4 offset:46848
    ds_read_b128 v[8:11], v6 offset:0
    buffer_load_dwordx4 v[236:239], v59, s[44:47], s68 offen offset:3072
    s_waitcnt lgkmcnt(7)
    v_mfma_f32_32x32x16_bf16 v[80:95], v[120:123], v[176:179], v[80:95]
    s_waitcnt lgkmcnt(0)
    v_min3_u32 v8, v8, v9, v10
    v_min_u32 v8, v8, v11
    s_nop 0
    v_readfirstlane_b32 s78, v8
    s_nop 0
    s_cmp_ge_u32 s78, 3
    s_cbranch_scc1 L_wd_6
    s_mov_b32 s79, 0
L_w_5:
    ds_read_b128 v[8:11], v6 offset:0
    s_waitcnt lgkmcnt(0)
    v_min3_u32 v8, v8, v9, v10
    v_min_u32 v8, v8, v11
    s_nop 0
    v_readfirstlane_b32 s78, v8
    s_nop 0
    s_cmp_ge_u32 s78, 3
    s_cbranch_scc1 L_wd_6
    s_add_u32 s79, s79, 1
    s_cmp_lt_u32 s79, 200000
    s_cbranch_scc1 L_w_5
L_wd_6:
    ds_read_b64_tr_b16 v[112:113], v4 offset:16384
    ds_read_b64_tr_b16 v[114:115], v4 offset:16640
    s_waitcnt vmcnt(12)
    v_cndmask_b32 v36, v196, v192, s[70:71]
    v_cndmask_b32 v37, v197, v193, s[70:71]
    v_cndmask_b32 v38, v198, v194, s[70:71]
    v_cndmask_b32 v39, v199, v195, s[70:71]
    v_cndmask_b32 v40, v200, v204, s[70:71]
    v_cndmask_b32 v41, v201, v205, s[70:71]
    v_cndmask_b32 v42, v202, v206, s[70:71]
    v_cndmask_b32 v43, v203, v207, s[70:71]
    v_cndmask_b32 v44, v204, v200, s[70:71]
    v_cndmask_b32 v45, v205, v201, s[70:71]
    v_cndmask_b32 v46, v206, v202, s[70:71]
    s_add_u32 s68, s63, 7
    s_and_b32 s68, s68, 7
    s_lshl_b32 s68, s68, 7
    buffer_load_dwordx4 v[240:243], v56, s[44:47], s68 offen offset:0
    s_waitcnt lgkmcnt(7)
    v_mfma_f32_32x32x16_bf16 v[80:95], v[124:127], v[180:183], v[80:95]
    ds_read_b64_tr_b16 v[116:117], v4 offset:16896
    ds_read_b64_tr_b16 v[118:119], v4 offset:17152
    v_cndmask_b32 v47, v207, v203, s[70:71]
    v_cndmask_b32 v32, v192, v196, s[70:71]
    v_cndmask_b32 v33, v193, v197, s[70:71]
    v_cndmask_b32 v34, v194, v198, s[70:71]
    v_cndmask_b32 v35, v195, v199, s[70:71]
    v_cndmask_b32 v196, v36, v44, s[72:73]
    v_cndmask_b32 v197, v37, v45, s[72:73]
    v_cndmask_b32 v198, v38, v46, s[72:73]
    v_cndmask_b32 v199, v39, v47, s[72:73]
    v_cndmask_b32 v200, v40, v32, s[72:73]
    v_cndmask_b32 v201, v41, v33, s[72:73]
    buffer_load_dwordx4 v[244:247], v57, s[44:47], s68 offen offset:1024
    s_waitcnt lgkmcnt(7)
    v_mfma_f32_32x32x16_bf16 v[80:95], v[104:107], v[184:187], v[80:95]
    ds_read_b64_tr_b16 v[120:121], v4 offset:17408
    ds_read_b64_tr_b16 v[122:123], v4 offset:17664
    v_cndmask_b32 v202, v42, v34, s[72:73]
    v_cndmask_b32 v203, v43, v35, s[72:73]
    v_cndmask_b32 v204, v44, v36, s[72:73]
    v_cndmask_b32 v205, v45, v37, s[72:73]
    v_cndmask_b32 v206, v46, v38, s[72:73]
    v_cndmask_b32 v207, v47, v39, s[72:73]
    v_cndmask_b32 v192, v32, v40, s[72:73]
    v_cndmask_b32 v193, v33, v41, s[72:73]
    v_cndmask_b32 v194, v34, v42, s[72:73]
    v_cndmask_b32 v195, v35, v43, s[72:73]
    v_mov_b32_dpp v196, v196 quad_perm:[1,0,3,2] row_mask:0xf bank_mask:0xf
    buffer_load_dwordx4 v[248:251], v58, s[44:47], s68 offen offset:2048
    s_waitcnt lgkmcnt(7)
    v_mfma_f32_32x32x16_bf16 v[80:95], v[108:111], v[188:191], v[80:95]
    ds_read_b64_tr_b16 v[124:125], v4 offset:17920
    ds_read_b64_tr_b16 v[126:127], v4 offset:18176
    v_mov_b32_dpp v197, v197 quad_perm:[1,0,3,2] row_mask:0xf bank_mask:0xf
    v_mov_b32_dpp v198, v198 quad_perm:[1,0,3,2] row_mask:0xf bank_mask:0xf
    v_mov_b32_dpp v199, v199 quad_perm:[1,0,3,2] row_mask:0xf bank_mask:0xf
    v_mov_b32_dpp v200, v200 quad_perm:[2,3,0,1] row_mask:0xf bank_mask:0xf
    v_mov_b32_dpp v201, v201 quad_perm:[2,3,0,1] row_mask:0xf bank_mask:0xf
    v_mov_b32_dpp v202, v202 quad_perm:[2,3,0,1] row_mask:0xf bank_mask:0xf
    v_mov_b32_dpp v203, v203 quad_perm:[2,3,0,1] row_mask:0xf bank_mask:0xf
    v_mov_b32_dpp v204, v204 quad_perm:[3,2,1,0] row_mask:0xf bank_mask:0xf
    v_mov_b32_dpp v205, v205 quad_perm:[3,2,1,0] row_mask:0xf bank_mask:0xf
    v_mov_b32_dpp v206, v206 quad_perm:[3,2,1,0] row_mask:0xf bank_mask:0xf
    v_mov_b32_dpp v207, v207 quad_perm:[3,2,1,0] row_mask:0xf bank_mask:0xf
    buffer_load_dwordx4 v[252:255], v59, s[44:47], s68 offen offset:3072
    s_waitcnt lgkmcnt(6)
    v_mfma_f32_32x32x16_bf16 v[64:79], v[112:115], v[192:195], v[64:79]
    ds_read_b64_tr_b16 v[104:105], v4 offset:49152
    ds_read_b64_tr_b16 v[106:107], v4 offset:49408
    s_mov_b32 m0, 159232
    s_nop 0
    buffer_load_dwordx4 v15, s[52:55], 0 offen lds
    s_waitcnt lgkmcnt(6)
    v_mfma_f32_32x32x16_bf16 v[64:79], v[116:119], v[196:199], v[64:79]
    ds_read_b64_tr_b16 v[108:109], v4 offset:49664
    ds_read_b64_tr_b16 v[110:111], v4 offset:49920
    s_add_u32 s64, s63, 0
    s_and_b32 s64, s64, 7
    s_mul_i32 s65, s64, 196608
    s_add_u32 s65, s65, s66
    s_add_u32 m0, s67, 65536
    s_nop 0
    buffer_load_dwordx4 v3, s[48:51], s65 offen lds
    s_waitcnt lgkmcnt(6)
    v_mfma_f32_32x32x16_bf16 v[64:79], v[120:123], v[200:203], v[64:79]
    ds_read_b64_tr_b16 v[112:113], v4 offset:50176
    ds_read_b64_tr_b16 v[114:115], v4 offset:50432
    s_add_u32 s64, s63, 1
    s_and_b32 s64, s64, 7
    s_mul_i32 s65, s64, 196608
    s_add_u32 s65, s65, s66
    s_add_u32 m0, s67, 69632
    s_nop 0
    buffer_load_dwordx4 v3, s[48:51], s65 offen lds
    s_waitcnt lgkmcnt(6)
    v_mfma_f32_32x32x16_bf16 v[64:79], v[124:127], v[204:207], v[64:79]
    ds_read_b64_tr_b16 v[116:117], v4 offset:50688
    ds_read_b64_tr_b16 v[118:119], v4 offset:50944
    s_add_u32 s64, s63, 2
    s_and_b32 s64, s64, 7
    s_mul_i32 s65, s64, 196608
    s_add_u32 s65, s65, s66
    s_add_u32 m0, s67, 73728
    s_nop 0
    buffer_load_dwordx4 v3, s[48:51], s65 offen lds
    s_waitcnt lgkmcnt(6)
    v_mfma_f32_32x32x16_bf16 v[80:95], v[104:107], v[192:195], v[80:95]
    ds_read_b64_tr_b16 v[120:121], v4 offset:20480
    ds_read_b64_tr_b16 v[122:123], v4 offset:20736
    s_waitcnt vmcnt(16)
    v_cndmask_b32 v36, v212, v208, s[70:71]
    v_cndmask_b32 v37, v213, v209, s[70:71]
    v_cndmask_b32 v38, v214, v210, s[70:71]
    v_cndmask_b32 v39, v215, v211, s[70:71]
    v_cndmask_b32 v40, v216, v220, s[70:71]
    v_cndmask_b32 v41, v217, v221, s[70:71]
    v_cndmask_b32 v42, v218, v222, s[70:71]
    v_cndmask_b32 v43, v219, v223, s[70:71]
    v_cndmask_b32 v44, v220, v216, s[70:71]
    v_cndmask_b32 v45, v221, v217, s[70:71]
    v_cndmask_b32 v46, v222, v218, s[70:71]
    s_add_u32 s64, s63, 3
    s_and_b32 s64, s64, 7
    s_mul_i32 s65, s64, 196608
    s_add_u32 s65, s65, s66
    s_add_u32 m0, s67, 77824
    s_nop 0
    buffer_load_dwordx4 v3, s[48:51], s65 offen lds
    s_waitcnt lgkmcnt(6)
    v_mfma_f32_32x32x16_bf16 v[80:95], v[108:111], v[196:199], v[80:95]
    ds_read_b64_tr_b16 v[124:125], v4 offset:20992
    ds_read_b64_tr_b16 v[126:127], v4 offset:21248
    v_cndmask_b32 v47, v223, v219, s[70:71]
    v_cndmask_b32 v32, v208, v212, s[70:71]
    v_cndmask_b32 v33, v209, v213, s[70:71]
    v_cndmask_b32 v34, v210, v214, s[70:71]
    v_cndmask_b32 v35, v211, v215, s[70:71]
    v_cndmask_b32 v212, v36, v44, s[72:73]
    v_cndmask_b32 v213, v37, v45, s[72:73]
    v_cndmask_b32 v214, v38, v46, s[72:73]
    v_cndmask_b32 v215, v39, v47, s[72:73]
    v_cndmask_b32 v216, v40, v32, s[72:73]
    v_cndmask_b32 v217, v41, v33, s[72:73]
    s_waitcnt lgkmcnt(6)
    v_mfma_f32_32x32x16_bf16 v[80:95], v[112:115], v[200:203], v[80:95]
    ds_read_b64_tr_b16 v[104:105], v4 offset:21504
    ds_read_b64_tr_b16 v[106:107], v4 offset:21760
    v_cndmask_b32 v218, v42, v34, s[72:73]
    v_cndmask_b32 v219, v43, v35, s[72:73]
    v_cndmask_b32 v220, v44, v36, s[72:73]
    v_cndmask_b32 v221, v45, v37, s[72:73]
    v_cndmask_b32 v222, v46, v38, s[72:73]
    v_cndmask_b32 v223, v47, v39, s[72:73]
    v_cndmask_b32 v208, v32, v40, s[72:73]
    v_cndmask_b32 v209, v33, v41, s[72:73]
    v_cndmask_b32 v210, v34, v42, s[72:73]
    v_cndmask_b32 v211, v35, v43, s[72:73]
    v_mov_b32_dpp v212, v212 quad_perm:[1,0,3,2] row_mask:0xf bank_mask:0xf
    s_add_u32 s64, s63, 4
    s_and_b32 s64, s64, 7
    s_mul_i32 s65, s64, 196608
    s_add_u32 s65, s65, s66
    s_add_u32 m0, s67, 81920
    s_nop 0
    buffer_load_dwordx4 v3, s[48:51], s65 offen lds
    s_waitcnt lgkmcnt(6)
    v_mfma_f32_32x32x16_bf16 v[80:95], v[116:119], v[204:207], v[80:95]
    ds_read_b64_tr_b16 v[108:109], v4 offset:22016
    ds_read_b64_tr_b16 v[110:111], v4 offset:22272
    v_mov_b32_dpp v213, v213 quad_perm:[1,0,3,2] row_mask:0xf bank_mask:0xf
    v_mov_b32_dpp v214, v214 quad_perm:[1,0,3,2] row_mask:0xf bank_mask:0xf
    v_mov_b32_dpp v215, v215 quad_perm:[1,0,3,2] row_mask:0xf bank_mask:0xf
    v_mov_b32_dpp v216, v216 quad_perm:[2,3,0,1] row_mask:0xf bank_mask:0xf
    v_mov_b32_dpp v217, v217 quad_perm:[2,3,0,1] row_mask:0xf bank_mask:0xf
    v_mov_b32_dpp v218, v218 quad_perm:[2,3,0,1] row_mask:0xf bank_mask:0xf
    v_mov_b32_dpp v219, v219 quad_perm:[2,3,0,1] row_mask:0xf bank_mask:0xf
    v_mov_b32_dpp v220, v220 quad_perm:[3,2,1,0] row_mask:0xf bank_mask:0xf
    v_mov_b32_dpp v221, v221 quad_perm:[3,2,1,0] row_mask:0xf bank_mask:0xf
    v_mov_b32_dpp v222, v222 quad_perm:[3,2,1,0] row_mask:0xf bank_mask:0xf
    v_mov_b32_dpp v223, v223 quad_perm:[3,2,1,0] row_mask:0xf bank_mask:0xf
    s_waitcnt vmcnt(14)
    v_mov_b32 v12, 4
    s_mov_b64 exec, 1
    ds_write_b32 v7, v12
    s_mov_b64 exec, -1
    s_waitcnt lgkmcnt(7)
    v_mfma_f32_32x32x16_bf16 v[64:79], v[120:123], v[208:211], v[64:79]
    ds_read_b64_tr_b16 v[112:113], v4 offset:53248
    ds_read_b64_tr_b16 v[114:115], v4 offset:53504
    s_add_u32 s64, s63, 5
    s_and_b32 s64, s64, 7
    s_mul_i32 s65, s64, 196608
    s_add_u32 s65, s65, s66
    s_add_u32 m0, s67, 86016
    s_nop 0
    buffer_load_dwordx4 v3, s[48:51], s65 offen lds
    s_waitcnt lgkmcnt(7)
    v_mfma_f32_32x32x16_bf16 v[64:79], v[124:127], v[212:215], v[64:79]
    ds_read_b64_tr_b16 v[116:117], v4 offset:53760
    ds_read_b64_tr_b16 v[118:119], v4 offset:54016
    s_add_u32 s64, s63, 6
    s_and_b32 s64, s64, 7
    s_mul_i32 s65, s64, 196608
    s_add_u32 s65, s65, s66
    s_add_u32 m0, s67, 90112
    s_nop 0
    buffer_load_dwordx4 v3, s[48:51], s65 offen lds
    s_waitcnt lgkmcnt(7)
    v_mfma_f32_32x32x16_bf16 v[64:79], v[104:107], v[216:219], v[64:79]
    ds_read_b64_tr_b16 v[120:121], v4 offset:54272
    ds_read_b64_tr_b16 v[122:123], v4 offset:54528
    s_add_u32 s64, s63, 7
    s_and_b32 s64, s64, 7
    s_mul_i32 s65, s64, 196608
    s_add_u32 s65, s65, s66
    s_add_u32 m0, s67, 94208
    s_nop 0
    buffer_load_dwordx4 v3, s[48:51], s65 offen lds
    s_waitcnt lgkmcnt(7)
    v_mfma_f32_32x32x16_bf16 v[64:79], v[108:111], v[220:223], v[64:79]
    ds_read_b64_tr_b16 v[124:125], v4 offset:54784
    ds_read_b64_tr_b16 v[126:127], v4 offset:55040
    ds_read_b128 v[8:11], v6 offset:0
    s_waitcnt lgkmcnt(7)
    v_mfma_f32_32x32x16_bf16 v[80:95], v[112:115], v[208:211], v[80:95]
    s_waitcnt lgkmcnt(0)
    v_min3_u32 v8, v8, v9, v10
    v_min_u32 v8, v8, v11
    s_nop 0
    v_readfirstlane_b32 s78, v8
    s_nop 0
    s_cmp_ge_u32 s78, 4
    s_cbranch_scc1 L_wd_8
    s_mov_b32 s79, 0
L_w_7:
    ds_read_b128 v[8:11], v6 offset:0
    s_waitcnt lgkmcnt(0)
    v_min3_u32 v8, v8, v9, v10
    v_min_u32 v8, v8, v11
    s_nop 0
    v_readfirstlane_b32 s78, v8
    s_nop 0
    s_cmp_ge_u32 s78, 4
    s_cbranch_scc1 L_wd_8
    s_add_u32 s79, s79, 1
    s_cmp_lt_u32 s79, 200000
    s_cbranch_scc1 L_w_7
L_wd_8:
    ds_read_b64_tr_b16 v[104:105], v4 offset:24576
    ds_read_b64_tr_b16 v[106:107], v4 offset:24832
    s_waitcnt vmcnt(13)
    v_cndmask_b32 v36, v228, v224, s[70:71]
    v_cndmask_b32 v37, v229, v225, s[70:71]
    v_cndmask_b32 v38, v230, v226, s[70:71]
    v_cndmask_b32 v39, v231, v227, s[70:71]
    v_cndmask_b32 v40, v232, v236, s[70:71]
    v_cndmask_b32 v41, v233, v237, s[70:71]
    v_cndmask_b32 v42, v234, v238, s[70:71]
    v_cndmask_b32 v43, v235, v239, s[70:71]
    v_cndmask_b32 v44, v236, v232, s[70:71]
    v_cndmask_b32 v45, v237, v233, s[70:71]
    v_cndmask_b32 v46, v238, v234, s[70:71]
    s_waitcnt lgkmcnt(7)
    v_mfma_f32_32x32x16_bf16 v[80:95], v[116:119], v[212:215], v[80:95]
    ds_read_b64_tr_b16 v[108:109], v4 offset:25088
    ds_read_b64_tr_b16 v[110:111], v4 offset:25344
    v_cndmask_b32 v47, v239, v235, s[70:71]
    v_cndmask_b32 v32, v224, v228, s[70:71]
    v_cndmask_b32 v33, v225, v229, s[70:71]
    v_cndmask_b32 v34, v226, v230, s[70:71]
    v_cndmask_b32 v35, v227, v231, s[70:71]
    v_cndmask_b32 v228, v36, v44, s[72:73]
    v_cndmask_b32 v229, v37, v45, s[72:73]
    v_cndmask_b32 v230, v38, v46, s[72:73]
    v_cndmask_b32 v231, v39, v47, s[72:73]
    v_cndmask_b32 v232, v40, v32, s[72:73]
    v_cndmask_b32 v233, v41, v33, s[72:73]
    s_waitcnt lgkmcnt(7)
    v_mfma_f32_32x32x16_bf16 v[80:95], v[120:123], v[216:219], v[80:95]
    ds_read_b64_tr_b16 v[112:113], v4 offset:25600
    ds_read_b64_tr_b16 v[114:115], v4 offset:25856
    v_cndmask_b32 v234, v42, v34, s[72:73]
    v_cndmask_b32 v235, v43, v35, s[72:73]
    v_cndmask_b32 v236, v44, v36, s[72:73]
    v_cndmask_b32 v237, v45, v37, s[72:73]
    v_cndmask_b32 v238, v46, v38, s[72:73]
    v_cndmask_b32 v239, v47, v39, s[72:73]
    v_cndmask_b32 v224, v32, v40, s[72:73]
    v_cndmask_b32 v225, v33, v41, s[72:73]
    v_cndmask_b32 v226, v34, v42, s[72:73]
    v_cndmask_b32 v227, v35, v43, s[72:73]
    v_mov_b32_dpp v228, v228 quad_perm:[1,0,3,2] row_mask:0xf bank_mask:0xf
    s_waitcnt lgkmcnt(7)
    v_mfma_f32_32x32x16_bf16 v[80:95], v[124:127], v[220:223], v[80:95]
    ds_read_b64_tr_b16 v[116:117], v4 offset:26112
    ds_read_b64_tr_b16 v[118:119], v4 offset:26368
    v_mov_b32_dpp v229, v229 quad_perm:[1,0,3,2] row_mask:0xf bank_mask:0xf
    v_mov_b32_dpp v230, v230 quad_perm:[1,0,3,2] row_mask:0xf bank_mask:0xf
    v_mov_b32_dpp v231, v231 quad_perm:[1,0,3,2] row_mask:0xf bank_mask:0xf
    v_mov_b32_dpp v232, v232 quad_perm:[2,3,0,1] row_mask:0xf bank_mask:0xf
    v_mov_b32_dpp v233, v233 quad_perm:[2,3,0,1] row_mask:0xf bank_mask:0xf
    v_mov_b32_dpp v234, v234 quad_perm:[2,3,0,1] row_mask:0xf bank_mask:0xf
    v_mov_b32_dpp v235, v235 quad_perm:[2,3,0,1] row_mask:0xf bank_mask:0xf
    v_mov_b32_dpp v236, v236 quad_perm:[3,2,1,0] row_mask:0xf bank_mask:0xf
    v_mov_b32_dpp v237, v237 quad_perm:[3,2,1,0] row_mask:0xf bank_mask:0xf
    v_mov_b32_dpp v238, v238 quad_perm:[3,2,1,0] row_mask:0xf bank_mask:0xf
    v_mov_b32_dpp v239, v239 quad_perm:[3,2,1,0] row_mask:0xf bank_mask:0xf
    s_waitcnt lgkmcnt(6)
    v_mfma_f32_32x32x16_bf16 v[64:79], v[104:107], v[224:227], v[64:79]
    ds_read_b64_tr_b16 v[120:121], v4 offset:57344
    ds_read_b64_tr_b16 v[122:123], v4 offset:57600
    s_waitcnt lgkmcnt(6)
    v_mfma_f32_32x32x16_bf16 v[64:79], v[108:111], v[228:231], v[64:79]
    ds_read_b64_tr_b16 v[124:125], v4 offset:57856
    ds_read_b64_tr_b16 v[126:127], v4 offset:58112
    s_waitcnt lgkmcnt(6)
    v_mfma_f32_32x32x16_bf16 v[64:79], v[112:115], v[232:235], v[64:79]
    ds_read_b64_tr_b16 v[104:105], v4 offset:58368
    ds_read_b64_tr_b16 v[106:107], v4 offset:58624
    s_waitcnt lgkmcnt(6)
    v_mfma_f32_32x32x16_bf16 v[64:79], v[116:119], v[236:239], v[64:79]
    ds_read_b64_tr_b16 v[108:109], v4 offset:58880
    ds_read_b64_tr_b16 v[110:111], v4 offset:59136
    s_waitcnt lgkmcnt(6)
    v_mfma_f32_32x32x16_bf16 v[80:95], v[120:123], v[224:227], v[80:95]
    ds_read_b64_tr_b16 v[112:113], v4 offset:28672
    ds_read_b64_tr_b16 v[114:115], v4 offset:28928
    s_waitcnt vmcnt(9)
    v_cndmask_b32 v36, v244, v240, s[70:71]
    v_cndmask_b32 v37, v245, v241, s[70:71]
    v_cndmask_b32 v38, v246, v242, s[70:71]
    v_cndmask_b32 v39, v247, v243, s[70:71]
    v_cndmask_b32 v40, v248, v252, s[70:71]
    v_cndmask_b32 v41, v249, v253, s[70:71]
    v_cndmask_b32 v42, v250, v254, s[70:71]
    v_cndmask_b32 v43, v251, v255, s[70:71]
    v_cndmask_b32 v44, v252, v248, s[70:71]
    v_cndmask_b32 v45, v253, v249, s[70:71]
    v_cndmask_b32 v46, v254, v250, s[70:71]
    s_waitcnt lgkmcnt(6)
    v_mfma_f32_32x32x16_bf16 v[80:95], v[124:127], v[228:231], v[80:95]
    ds_read_b64_tr_b16 v[116:117], v4 offset:29184
    ds_read_b64_tr_b16 v[118:119], v4 offset:29440
    v_cndmask_b32 v47, v255, v251, s[70:71]
    v_cndmask_b32 v32, v240, v244, s[70:71]
    v_cndmask_b32 v33, v241, v245, s[70:71]
    v_cndmask_b32 v34, v242, v246, s[70:71]
    v_cndmask_b32 v35, v243, v247, s[70:71]
    v_cndmask_b32 v244, v36, v44, s[72:73]
    v_cndmask_b32 v245, v37, v45, s[72:73]
    v_cndmask_b32 v246, v38, v46, s[72:73]
    v_cndmask_b32 v247, v39, v47, s[72:73]
    v_cndmask_b32 v248, v40, v32, s[72:73]
    v_cndmask_b32 v249, v41, v33, s[72:73]
    s_waitcnt lgkmcnt(6)
    v_mfma_f32_32x32x16_bf16 v[80:95], v[104:107], v[232:235], v[80:95]
    ds_read_b64_tr_b16 v[120:121], v4 offset:29696
    ds_read_b64_tr_b16 v[122:123], v4 offset:29952
    v_cndmask_b32 v250, v42, v34, s[72:73]
    v_cndmask_b32 v251, v43, v35, s[72:73]
    v_cndmask_b32 v252, v44, v36, s[72:73]
    v_cndmask_b32 v253, v45, v37, s[72:73]
    v_cndmask_b32 v254, v46, v38, s[72:73]
    v_cndmask_b32 v255, v47, v39, s[72:73]
    v_cndmask_b32 v240, v32, v40, s[72:73]
    v_cndmask_b32 v241, v33, v41, s[72:73]
    v_cndmask_b32 v242, v34, v42, s[72:73]
    v_cndmask_b32 v243, v35, v43, s[72:73]
    v_mov_b32_dpp v244, v244 quad_perm:[1,0,3,2] row_mask:0xf bank_mask:0xf
    s_waitcnt lgkmcnt(6)
    v_mfma_f32_32x32x16_bf16 v[80:95], v[108:111], v[236:239], v[80:95]
    ds_read_b64_tr_b16 v[124:125], v4 offset:30208
    ds_read_b64_tr_b16 v[126:127], v4 offset:30464
    v_mov_b32_dpp v245, v245 quad_perm:[1,0,3,2] row_mask:0xf bank_mask:0xf
    v_mov_b32_dpp v246, v246 quad_perm:[1,0,3,2] row_mask:0xf bank_mask:0xf
    v_mov_b32_dpp v247, v247 quad_perm:[1,0,3,2] row_mask:0xf bank_mask:0xf
    v_mov_b32_dpp v248, v248 quad_perm:[2,3,0,1] row_mask:0xf bank_mask:0xf
    v_mov_b32_dpp v249, v249 quad_perm:[2,3,0,1] row_mask:0xf bank_mask:0xf
    v_mov_b32_dpp v250, v250 quad_perm:[2,3,0,1] row_mask:0xf bank_mask:0xf
    v_mov_b32_dpp v251, v251 quad_perm:[2,3,0,1] row_mask:0xf bank_mask:0xf
    v_mov_b32_dpp v252, v252 quad_perm:[3,2,1,0] row_mask:0xf bank_mask:0xf
    v_mov_b32_dpp v253, v253 quad_perm:[3,2,1,0] row_mask:0xf bank_mask:0xf
    v_mov_b32_dpp v254, v254 quad_perm:[3,2,1,0] row_mask:0xf bank_mask:0xf
    v_mov_b32_dpp v255, v255 quad_perm:[3,2,1,0] row_mask:0xf bank_mask:0xf
    s_waitcnt lgkmcnt(6)
    v_mfma_f32_32x32x16_bf16 v[64:79], v[112:115], v[240:243], v[64:79]
    ds_read_b64_tr_b16 v[104:105], v4 offset:61440
    ds_read_b64_tr_b16 v[106:107], v4 offset:61696
    s_waitcnt vmcnt(8)
    ds_read_b64_tr_b16 v[48:49], v62
    ds_read_b64_tr_b16 v[50:51], v62 offset:256
    s_waitcnt lgkmcnt(8)
    v_mfma_f32_32x32x16_bf16 v[64:79], v[116:119], v[244:247], v[64:79]
    ds_read_b64_tr_b16 v[108:109], v4 offset:61952
    ds_read_b64_tr_b16 v[110:111], v4 offset:62208
    s_waitcnt lgkmcnt(8)
    v_mfma_f32_32x32x16_bf16 v[64:79], v[120:123], v[248:251], v[64:79]
    ds_read_b64_tr_b16 v[112:113], v4 offset:62464
    ds_read_b64_tr_b16 v[114:115], v4 offset:62720
    s_waitcnt lgkmcnt(8)
    v_mfma_f32_32x32x16_bf16 v[64:79], v[124:127], v[252:255], v[64:79]
    ds_read_b64_tr_b16 v[116:117], v4 offset:62976
    ds_read_b64_tr_b16 v[118:119], v4 offset:63232
    s_waitcnt lgkmcnt(6)
    v_cndmask_b32 v96, 0, v48, s[74:75]
    v_cndmask_b32 v100, v48, 0, s[74:75]
    v_cndmask_b32 v97, 0, v49, s[74:75]
    v_cndmask_b32 v101, v49, 0, s[74:75]
    v_cndmask_b32 v98, 0, v50, s[74:75]
    v_cndmask_b32 v102, v50, 0, s[74:75]
    v_cndmask_b32 v99, 0, v51, s[74:75]
    v_cndmask_b32 v103, v51, 0, s[74:75]
    v_mov_b32 v14, v60
    v_mov_b32 v15, v61
    v_cvt_pk_bf16_f32 v32, v64, v65
    v_cvt_pk_bf16_f32 v33, v66, v67
    v_cvt_pk_bf16_f32 v34, v68, v69
    v_cvt_pk_bf16_f32 v35, v70, v71
    v_cvt_pk_bf16_f32 v36, v72, v73
    v_cvt_pk_bf16_f32 v37, v74, v75
    v_cvt_pk_bf16_f32 v38, v76, v77
    v_cvt_pk_bf16_f32 v39, v78, v79
    v_mfma_f32_32x32x16_bf16 v[64:79], v[96:99], v[32:35], 0
    s_nop 0
    v_mfma_f32_32x32x16_bf16 v[64:79], v[100:103], v[36:39], v[64:79]
    s_nop 11
    v_max3_f32 v16, v64, v65, v66
    v_max3_f32 v17, v72, v73, v74
    v_min3_f32 v18, v64, v65, v66
    v_min3_f32 v19, v72, v73, v74
    v_max3_f32 v16, v16, v67, v68
    v_max3_f32 v17, v17, v75, v76
    v_min3_f32 v18, v18, v67, v68
    v_min3_f32 v19, v19, v75, v76
    v_max3_f32 v16, v16, v69, v70
    v_max3_f32 v17, v17, v77, v78
    s_waitcnt lgkmcnt(8)
    v_mfma_f32_32x32x16_bf16 v[80:95], v[104:107], v[240:243], v[80:95]
    v_min3_f32 v18, v18, v69, v70
    v_min3_f32 v19, v19, v77, v78
    v_max_f32 v16, v16, v71
    v_max_f32 v17, v17, v79
    v_min_f32 v18, v18, v71
    v_min_f32 v19, v19, v79
    s_waitcnt lgkmcnt(4)
    v_mfma_f32_32x32x16_bf16 v[80:95], v[108:111], v[244:247], v[80:95]
    v_permlane32_swap_b32 v16, v17
    v_permlane32_swap_b32 v18, v19
    v_max_f32 v20, v16, v17
    v_min_f32 v22, v18, v19
    v_mul_f32 v21, s62, v20
    v_mul_f32 v23, s62, v22
    s_waitcnt lgkmcnt(2)
    v_mfma_f32_32x32x16_bf16 v[80:95], v[112:115], v[248:251], v[80:95]
    v_mul_f32 v20, s62, v20
    v_mul_f32 v22, s62, v22
    s_nop 0
    v_permlane32_swap_b32 v20, v21
    v_permlane32_swap_b32 v22, v23
    v_fma_f32 v32, v64, s62, -v20
    v_fma_f32 v40, v72, s62, -v21
    s_waitcnt lgkmcnt(0)
    v_mfma_f32_32x32x16_bf16 v[80:95], v[116:119], v[252:255], v[80:95]
    v_fma_f32 v48, -v64, s62, v22
    v_exp_f32 v32, v32
    v_fma_f32 v56, -v72, s62, v23
    v_exp_f32 v40, v40
    v_fma_f32 v33, v65, s62, -v20
    v_exp_f32 v48, v48
    v_fma_f32 v41, v73, s62, -v21
    v_exp_f32 v56, v56
    v_fma_f32 v49, -v65, s62, v22
    v_exp_f32 v33, v33
    v_fma_f32 v57, -v73, s62, v23
    v_exp_f32 v41, v41
    v_fma_f32 v34, v66, s62, -v20
    v_exp_f32 v49, v49
    v_add_f32 v24, v32, v33
    v_fma_f32 v42, v74, s62, -v21
    v_exp_f32 v57, v57
    v_add_f32 v25, v40, v41
    v_cvt_pk_bf16_f32 v104, v80, v81
    v_cvt_pk_bf16_f32 v105, v82, v83
    v_cvt_pk_bf16_f32 v106, v84, v85
    v_cvt_pk_bf16_f32 v107, v86, v87
    v_cvt_pk_bf16_f32 v108, v88, v89
    v_cvt_pk_bf16_f32 v109, v90, v91
    v_cvt_pk_bf16_f32 v110, v92, v93
    v_cvt_pk_bf16_f32 v111, v94, v95
    ds_write_b128 v15, v[104:107] offset:0
    ds_write_b128 v15, v[108:111] offset:1024
    v_fma_f32 v50, -v66, s62, v22
    v_exp_f32 v34, v34
    v_add_f32 v26, v48, v49
    v_fma_f32 v58, -v74, s62, v23
    v_exp_f32 v42, v42
    v_add_f32 v27, v56, v57
    v_fma_f32 v35, v67, s62, -v20
    v_exp_f32 v50, v50
    v_add_f32 v24, v24, v34
    v_fma_f32 v43, v75, s62, -v21
    v_exp_f32 v58, v58
    v_add_f32 v25, v25, v42
    v_fma_f32 v51, -v67, s62, v22
    v_exp_f32 v35, v35
    v_add_f32 v26, v26, v50
    v_fma_f32 v59, -v75, s62, v23
    v_exp_f32 v43, v43
    v_add_f32 v27, v27, v58
    v_fma_f32 v36, v68, s62, -v20
    v_exp_f32 v51, v51
    v_add_f32 v24, v24, v35
    v_fma_f32 v44, v76, s62, -v21
    v_exp_f32 v59, v59
    v_add_f32 v25, v25, v43
    v_fma_f32 v52, -v68, s62, v22
    v_exp_f32 v36, v36
    v_add_f32 v26, v26, v51
    v_fma_f32 v60, -v76, s62, v23
    v_exp_f32 v44, v44
    v_add_f32 v27, v27, v59
    v_fma_f32 v37, v69, s62, -v20
    v_exp_f32 v52, v52
    v_add_f32 v24, v24, v36
    v_fma_f32 v45, v77, s62, -v21
    v_exp_f32 v60, v60
    v_add_f32 v25, v25, v44
    v_fma_f32 v53, -v69, s62, v22
    v_exp_f32 v37, v37
    v_add_f32 v26, v26, v52
    v_fma_f32 v61, -v77, s62, v23
    v_exp_f32 v45, v45
    v_add_f32 v27, v27, v60
    v_fma_f32 v38, v70, s62, -v20
    v_exp_f32 v53, v53
    v_add_f32 v24, v24, v37
    v_fma_f32 v46, v78, s62, -v21
    v_exp_f32 v61, v61
    v_add_f32 v25, v25, v45
    v_fma_f32 v54, -v70, s62, v22
    v_exp_f32 v38, v38
    v_add_f32 v26, v26, v53
    v_fma_f32 v62, -v78, s62, v23
    v_exp_f32 v46, v46
    v_add_f32 v27, v27, v61
    v_fma_f32 v39, v71, s62, -v20
    v_exp_f32 v54, v54
    v_add_f32 v24, v24, v38
    v_fma_f32 v47, v79, s62, -v21
    v_exp_f32 v62, v62
    v_add_f32 v25, v25, v46
    v_fma_f32 v55, -v71, s62, v22
    v_exp_f32 v39, v39
    v_add_f32 v26, v26, v54
    v_fma_f32 v63, -v79, s62, v23
    v_exp_f32 v47, v47
    v_add_f32 v27, v27, v62
    v_exp_f32 v55, v55
    v_add_f32 v24, v24, v39
    v_exp_f32 v63, v63
    v_add_f32 v25, v25, v47
    v_add_f32 v26, v26, v55
    v_add_f32 v27, v27, v63
    v_permlane32_swap_b32 v24, v25
    s_nop 0
    v_permlane32_swap_b32 v26, v27
    v_add_f32 v16, v24, v25
    v_add_f32 v18, v26, v27
    v_rcp_f32 v16, v16
    v_rcp_f32 v18, v18
    v_mov_b32 v17, v16
    v_mov_b32 v19, v18
    s_nop 0
    v_permlane32_swap_b32 v16, v17
    v_permlane32_swap_b32 v18, v19
    v_mul_f32 v32, v32, v16
    v_mul_f32 v33, v33, v16
    v_mul_f32 v34, v34, v16
    v_mul_f32 v35, v35, v16
    v_mul_f32 v36, v36, v16
    v_mul_f32 v37, v37, v16
    v_mul_f32 v38, v38, v16
    v_mul_f32 v39, v39, v16
    v_cvt_pk_bf16_f32 v64, v32, v33
    v_cvt_pk_bf16_f32 v65, v34, v35
    v_cvt_pk_bf16_f32 v66, v36, v37
    v_cvt_pk_bf16_f32 v67, v38, v39
    ds_write_b128 v14, v[64:67] offset:0
    v_mul_f32 v48, v48, v18
    v_mul_f32 v49, v49, v18
    v_mul_f32 v50, v50, v18
    v_mul_f32 v51, v51, v18
    v_mul_f32 v52, v52, v18
    v_mul_f32 v53, v53, v18
    v_mul_f32 v54, v54, v18
    v_mul_f32 v55, v55, v18
    v_cvt_pk_bf16_f32 v68, v48, v49
    v_cvt_pk_bf16_f32 v69, v50, v51
    v_cvt_pk_bf16_f32 v70, v52, v53
    v_cvt_pk_bf16_f32 v71, v54, v55
    ds_write_b128 v14, v[68:71] offset:4096
    v_mul_f32 v40, v40, v17
    v_mul_f32 v41, v41, v17
    v_mul_f32 v42, v42, v17
    v_mul_f32 v43, v43, v17
    v_mul_f32 v44, v44, v17
    v_mul_f32 v45, v45, v17
    v_mul_f32 v46, v46, v17
    v_mul_f32 v47, v47, v17
    v_cvt_pk_bf16_f32 v72, v40, v41
    v_cvt_pk_bf16_f32 v73, v42, v43
    v_cvt_pk_bf16_f32 v74, v44, v45
    v_cvt_pk_bf16_f32 v75, v46, v47
    ds_write_b128 v14, v[72:75] offset:8192
    v_mul_f32 v56, v56, v19
    v_mul_f32 v57, v57, v19
    v_mul_f32 v58, v58, v19
    v_mul_f32 v59, v59, v19
    v_mul_f32 v60, v60, v19
    v_mul_f32 v61, v61, v19
    v_mul_f32 v62, v62, v19
    v_mul_f32 v63, v63, v19
    v_cvt_pk_bf16_f32 v76, v56, v57
    v_cvt_pk_bf16_f32 v77, v58, v59
    v_cvt_pk_bf16_f32 v78, v60, v61
    v_cvt_pk_bf16_f32 v79, v62, v63
    ds_write_b128 v14, v[76:79] offset:12288
    v_mov_b32 v12, 9
    s_mov_b64 exec, 1
    ds_write_b32 v7, v12
    s_mov_b64 exec, -1
    v_lshrrev_b32 v16, 2, v1
    v_and_b32 v17, 3, v1
    v_lshlrev_b32 v16, 5, v16
    v_lshl_add_u32 v16, v17, 3, v16
    s_lshl_b32 s60, s39, 12
    s_lshr_b32 s61, s39, 1
    s_lshl_b32 s61, s61, 10
    s_add_u32 s61, s61, 98304
    v_add_u32 v18, s60, v16
    v_add_u32 v19, s61, v16
    v_mov_b32 v20, 0x3f803f80
    v_mov_b32 v21, 0x3f803f80
    v_mov_b32 v22, 0x3f803f80
    v_mov_b32 v23, 0x3f803f80
    ds_read_b32 v28, v6 offset:32
    s_mov_b32 s79, 0
L_w_9:
    ds_read_b128 v[8:11], v6 offset:0
    s_waitcnt lgkmcnt(0)
    v_min3_u32 v8, v8, v9, v10
    v_min_u32 v8, v8, v11
    s_nop 0
    v_readfirstlane_b32 s78, v8
    s_nop 0
    s_cmp_ge_u32 s78, 9
    s_cbranch_scc1 L_wd_10
    s_add_u32 s79, s79, 1
    s_cmp_lt_u32 s79, 200000
    s_cbranch_scc1 L_w_9
L_wd_10:
    ds_read_b64_tr_b16 v[32:33], v18 offset:0
    ds_read_b64_tr_b16 v[34:35], v18 offset:512
    ds_read_b64_tr_b16 v[36:37], v19 offset:0
    ds_read_b64_tr_b16 v[38:39], v19 offset:512
    ds_read_b64_tr_b16 v[40:41], v18 offset:1024
    ds_read_b64_tr_b16 v[42:43], v18 offset:1536
    ds_read_b64_tr_b16 v[44:45], v19 offset:4096
    ds_read_b64_tr_b16 v[46:47], v19 offset:4608
    ds_read_b64_tr_b16 v[48:49], v18 offset:2048
    ds_read_b64_tr_b16 v[50:51], v18 offset:2560
    ds_read_b64_tr_b16 v[52:53], v19 offset:8192
    ds_read_b64_tr_b16 v[54:55], v19 offset:8704
    ds_read_b64_tr_b16 v[56:57], v18 offset:3072
    ds_read_b64_tr_b16 v[58:59], v18 offset:3584
    ds_read_b64_tr_b16 v[60:61], v19 offset:12288
    ds_read_b64_tr_b16 v[62:63], v19 offset:12800
    s_lshl_b32 s60, s38, 4
    s_add_u32 s60, s60, s37
    s_mul_i32 s60, s60, 2304
    s_add_u32 s60, s60, 6356992
    s_lshl_b32 s61, s39, 9
    v_and_b32 v16, 15, v1
    v_lshrrev_b32 v24, 5, v1
    v_lshlrev_b32 v16, 4, v16
    v_lshl_add_u32 v16, v24, 8, v16
    v_add_u32 v16, s61, v16
    v_and_b32 v13, 31, v1
    v_lshlrev_b32 v13, 4, v13
    v_mul_u32_u24 v24, 2304, v24
    v_add3_u32 v13, v13, v24, s61
    s_lshl_b32 s61, s39, 6
    s_add_u32 s61, s61, 2048
    v_and_b32 v17, 0x30, v1
    v_add_u32 v17, s61, v17
    v_mov_b32 v15, v17
    s_waitcnt lgkmcnt(12)
    v_mfma_f32_16x16x32_bf16 v[104:107], v[32:35], v[36:39], 0
    v_mfma_f32_16x16x32_bf16 v[108:111], v[32:35], v[20:23], 0
    s_waitcnt lgkmcnt(8)
    v_mfma_f32_16x16x32_bf16 v[104:107], v[40:43], v[44:47], v[104:107]
    v_mfma_f32_16x16x32_bf16 v[108:111], v[40:43], v[20:23], v[108:111]
    s_waitcnt lgkmcnt(4)
    v_mfma_f32_16x16x32_bf16 v[104:107], v[48:51], v[52:55], v[104:107]
    v_mfma_f32_16x16x32_bf16 v[108:111], v[48:51], v[20:23], v[108:111]
    s_waitcnt lgkmcnt(0)
    v_mfma_f32_16x16x32_bf16 v[104:107], v[56:59], v[60:63], v[104:107]
    v_mfma_f32_16x16x32_bf16 v[108:111], v[56:59], v[20:23], v[108:111]
    s_waitcnt lgkmcnt(15)
    v_readfirstlane_b32 s78, v28
    s_nop 0
    s_cmp_ge_u32 s78, 4
    s_cbranch_scc1 L_wd_12
    s_mov_b32 s79, 0
L_w_11:
    ds_read_b32 v28, v6 offset:32
    s_waitcnt lgkmcnt(0)
    v_readfirstlane_b32 s78, v28
    s_nop 0
    s_cmp_ge_u32 s78, 4
    s_cbranch_scc1 L_wd_12
    s_add_u32 s79, s79, 1
    s_cmp_lt_u32 s79, 200000
    s_cbranch_scc1 L_w_11
L_wd_12:
    s_mov_b32 s68, 0x0000ffff
    s_mov_b32 s69, 0x0000ffff
    s_mov_b32 s74, 0x00010001
    s_mov_b32 s75, 0x00010001
    v_cvt_pk_bf16_f32 v112, v104, v105
    v_cvt_pk_bf16_f32 v113, v106, v107
    v_cvt_pk_bf16_f32 v114, v104, v105
    v_cvt_pk_bf16_f32 v115, v106, v107
    s_nop 0
    v_permlane16_swap_b32 v112, v114
    v_permlane16_swap_b32 v113, v115
    v_min_u32 v112, -2, v112
    v_min_u32 v113, -2, v113
    v_min_u32 v114, -2, v114
    v_min_u32 v115, -2, v115
    v_min_u32 v108, -2, v108
    v_min_u32 v109, -2, v109
    v_min_u32 v110, -2, v110
    v_min_u32 v111, -2, v111
    s_mov_b64 exec, s[68:69]
    buffer_store_dwordx4 v[112:115], v16, s[40:43], s60 offen sc1
    s_mov_b64 exec, s[74:75]
    buffer_store_dwordx4 v[108:111], v17, s[40:43], s60 offen sc1
    s_mov_b64 exec, -1
    s_waitcnt vmcnt(2)
    v_mov_b32 v12, 10
    s_mov_b64 exec, 1
    ds_write_b32 v7, v12
    s_mov_b64 exec, -1
    s_lshr_b32 s60, s38, 1
    s_lshl_b32 s60, s60, 7
    s_sub_u32 s61, 524288, s60
    s_add_u32 s52, s10, s60
    s_addc_u32 s53, s11, 0
    s_mov_b32 s54, s61
    s_mov_b32 s55, 0x00020000
    v_lshrrev_b32 v18, 3, v1
    v_and_b32 v19, 7, v1
    v_bfe_u32 v20, v1, 4, 1
    v_lshlrev_b32 v20, 2, v20
    v_xor_b32 v19, v19, v20
    v_lshlrev_b32 v2, 10, v18
    v_lshl_add_u32 v2, v19, 4, v2
    s_lshl_b32 s66, s39, 13
    s_mov_b32 s79, 0
L_w_13:
    ds_read_b128 v[8:11], v6 offset:0
    s_waitcnt lgkmcnt(0)
    v_min3_u32 v8, v8, v9, v10
    v_min_u32 v8, v8, v11
    s_nop 0
    v_readfirstlane_b32 s78, v8
    s_nop 0
    s_cmp_ge_u32 s78, 10
    s_cbranch_scc1 L_wd_14
    s_add_u32 s79, s79, 1
    s_cmp_lt_u32 s79, 200000
    s_cbranch_scc1 L_w_13
L_wd_14:
    ds_read_b64_tr_b16 v[32:33], v5 offset:0
    ds_read_b64_tr_b16 v[34:35], v5 offset:256
    ds_read_b64_tr_b16 v[36:37], v5 offset:512
    ds_read_b64_tr_b16 v[38:39], v5 offset:768
    ds_read_b64_tr_b16 v[40:41], v5 offset:1024
    ds_read_b64_tr_b16 v[42:43], v5 offset:1280
    ds_read_b64_tr_b16 v[44:45], v5 offset:1536
    ds_read_b64_tr_b16 v[46:47], v5 offset:1792
    ds_read_b64_tr_b16 v[48:49], v5 offset:4096
    ds_read_b64_tr_b16 v[50:51], v5 offset:4352
    ds_read_b64_tr_b16 v[52:53], v5 offset:4608
    ds_read_b64_tr_b16 v[54:55], v5 offset:4864
    v_and_b32 v16, 15, v1
    v_bfe_u32 v17, v1, 4, 1
    v_lshlrev_b32 v17, 3, v17
    v_sub_u32 v17, v16, v17
    v_and_b32 v18, 1, v17
    v_lshlrev_b32 v18, 4, v18
    v_mov_b32 v19, 0x3f80
    v_lshlrev_b32 v19, v18, v19
    v_ashrrev_i32 v17, 1, v17
    v_cmp_eq_u32 s[68:69], 0, v17
    s_nop 1
    v_cndmask_b32 v104, 0, v19, s[68:69]
    v_cmp_eq_u32 s[68:69], 1, v17
    s_nop 1
    v_cndmask_b32 v105, 0, v19, s[68:69]
    v_cmp_eq_u32 s[68:69], 2, v17
    s_nop 1
    v_cndmask_b32 v106, 0, v19, s[68:69]
    v_cmp_eq_u32 s[68:69], 3, v17
    s_nop 1
    v_cndmask_b32 v107, 0, v19, s[68:69]
    v_mul_u32_u24 v16, 2304, v16
    v_add_u32 v15, v15, v16
    s_waitcnt lgkmcnt(10)
    v_mfma_f32_32x32x16_bf16 v[80:95], v[32:35], v[128:131], 0
    ds_read_b64_tr_b16 v[56:57], v5 offset:5120
    ds_read_b64_tr_b16 v[58:59], v5 offset:5376
    s_add_u32 s68, s66, 0
    s_add_u32 m0, s67, 32768
    s_nop 0
    buffer_load_dwordx4 v2, s[52:55], s68 offen lds
    s_waitcnt lgkmcnt(10)
    v_mfma_f32_32x32x16_bf16 v[80:95], v[36:39], v[132:135], v[80:95]
    ds_read_b64_tr_b16 v[60:61], v5 offset:5632
    ds_read_b64_tr_b16 v[62:63], v5 offset:5888
    s_waitcnt lgkmcnt(10)
    v_mfma_f32_32x32x16_bf16 v[80:95], v[40:43], v[136:139], v[80:95]
    ds_read_b64_tr_b16 v[32:33], v5 offset:8192
    ds_read_b64_tr_b16 v[34:35], v5 offset:8448
    s_add_u32 s68, s66, 32768
    s_add_u32 m0, s67, 36864
    s_nop 0
    buffer_load_dwordx4 v2, s[52:55], s68 offen lds
    s_waitcnt lgkmcnt(10)
    v_mfma_f32_32x32x16_bf16 v[80:95], v[44:47], v[140:143], v[80:95]
    ds_read_b64_tr_b16 v[36:37], v5 offset:8704
    ds_read_b64_tr_b16 v[38:39], v5 offset:8960
    s_waitcnt lgkmcnt(10)
    v_mfma_f32_32x32x16_bf16 v[80:95], v[48:51], v[144:147], v[80:95]
    ds_read_b64_tr_b16 v[40:41], v5 offset:9216
    ds_read_b64_tr_b16 v[42:43], v5 offset:9472
    s_add_u32 s68, s66, 65536
    s_add_u32 m0, s67, 40960
    s_nop 0
    buffer_load_dwordx4 v2, s[52:55], s68 offen lds
    s_waitcnt lgkmcnt(10)
    v_mfma_f32_32x32x16_bf16 v[80:95], v[52:55], v[148:151], v[80:95]
    ds_read_b64_tr_b16 v[44:45], v5 offset:9728
    ds_read_b64_tr_b16 v[46:47], v5 offset:9984
    s_waitcnt lgkmcnt(10)
    v_mfma_f32_32x32x16_bf16 v[80:95], v[56:59], v[152:155], v[80:95]
    ds_read_b64_tr_b16 v[48:49], v5 offset:12288
    ds_read_b64_tr_b16 v[50:51], v5 offset:12544
    s_add_u32 s68, s66, 98304
    s_add_u32 m0, s67, 45056
    s_nop 0
    buffer_load_dwordx4 v2, s[52:55], s68 offen lds
    s_waitcnt lgkmcnt(10)
    v_mfma_f32_32x32x16_bf16 v[80:95], v[60:63], v[156:159], v[80:95]
    ds_read_b64_tr_b16 v[52:53], v5 offset:12800
    ds_read_b64_tr_b16 v[54:55], v5 offset:13056
    s_waitcnt lgkmcnt(10)
    v_mfma_f32_32x32x16_bf16 v[80:95], v[32:35], v[160:163], v[80:95]
    ds_read_b64_tr_b16 v[56:57], v5 offset:13312
    ds_read_b64_tr_b16 v[58:59], v5 offset:13568
    s_add_u32 s68, s66, 131072
    s_add_u32 m0, s67, 49152
    s_nop 0
    buffer_load_dwordx4 v2, s[52:55], s68 offen lds
    s_waitcnt lgkmcnt(10)
    v_mfma_f32_32x32x16_bf16 v[80:95], v[36:39], v[164:167], v[80:95]
    ds_read_b64_tr_b16 v[60:61], v5 offset:13824
    ds_read_b64_tr_b16 v[62:63], v5 offset:14080
    s_waitcnt lgkmcnt(10)
    v_mfma_f32_32x32x16_bf16 v[80:95], v[40:43], v[168:171], v[80:95]
    ds_read_b64_tr_b16 v[32:33], v5 offset:16384
    ds_read_b64_tr_b16 v[34:35], v5 offset:16640
    s_add_u32 s68, s66, 163840
    s_add_u32 m0, s67, 53248
    s_nop 0
    buffer_load_dwordx4 v2, s[52:55], s68 offen lds
    s_waitcnt lgkmcnt(10)
    v_mfma_f32_32x32x16_bf16 v[80:95], v[44:47], v[172:175], v[80:95]
    ds_read_b64_tr_b16 v[36:37], v5 offset:16896
    ds_read_b64_tr_b16 v[38:39], v5 offset:17152
    s_waitcnt lgkmcnt(10)
    v_mfma_f32_32x32x16_bf16 v[80:95], v[48:51], v[176:179], v[80:95]
    ds_read_b64_tr_b16 v[40:41], v5 offset:17408
    ds_read_b64_tr_b16 v[42:43], v5 offset:17664
    s_add_u32 s68, s66, 196608
    s_add_u32 m0, s67, 57344
    s_nop 0
    buffer_load_dwordx4 v2, s[52:55], s68 offen lds
    s_waitcnt lgkmcnt(10)
    v_mfma_f32_32x32x16_bf16 v[80:95], v[52:55], v[180:183], v[80:95]
    ds_read_b64_tr_b16 v[44:45], v5 offset:17920
    ds_read_b64_tr_b16 v[46:47], v5 offset:18176
    s_waitcnt lgkmcnt(10)
    v_mfma_f32_32x32x16_bf16 v[80:95], v[56:59], v[184:187], v[80:95]
    ds_read_b64_tr_b16 v[48:49], v5 offset:20480
    ds_read_b64_tr_b16 v[50:51], v5 offset:20736
    s_add_u32 s68, s66, 229376
    s_add_u32 m0, s67, 61440
    s_nop 0
    buffer_load_dwordx4 v2, s[52:55], s68 offen lds
    s_waitcnt lgkmcnt(10)
    v_mfma_f32_32x32x16_bf16 v[80:95], v[60:63], v[188:191], v[80:95]
    ds_read_b64_tr_b16 v[52:53], v5 offset:20992
    ds_read_b64_tr_b16 v[54:55], v5 offset:21248
    s_waitcnt lgkmcnt(10)
    v_mfma_f32_32x32x16_bf16 v[80:95], v[32:35], v[192:195], v[80:95]
    ds_read_b64_tr_b16 v[56:57], v5 offset:21504
    ds_read_b64_tr_b16 v[58:59], v5 offset:21760
    s_add_u32 s68, s66, 262144
    s_add_u32 m0, s67, 0
    s_nop 0
    buffer_load_dwordx4 v2, s[52:55], s68 offen lds
    s_waitcnt lgkmcnt(10)
    v_mfma_f32_32x32x16_bf16 v[80:95], v[36:39], v[196:199], v[80:95]
    ds_read_b64_tr_b16 v[60:61], v5 offset:22016
    ds_read_b64_tr_b16 v[62:63], v5 offset:22272
    s_waitcnt lgkmcnt(10)
    v_mfma_f32_32x32x16_bf16 v[80:95], v[40:43], v[200:203], v[80:95]
    ds_read_b64_tr_b16 v[32:33], v5 offset:24576
    ds_read_b64_tr_b16 v[34:35], v5 offset:24832
    s_add_u32 s68, s66, 294912
    s_add_u32 m0, s67, 4096
    s_nop 0
    buffer_load_dwordx4 v2, s[52:55], s68 offen lds
    s_waitcnt lgkmcnt(10)
    v_mfma_f32_32x32x16_bf16 v[80:95], v[44:47], v[204:207], v[80:95]
    ds_read_b64_tr_b16 v[36:37], v5 offset:25088
    ds_read_b64_tr_b16 v[38:39], v5 offset:25344
    s_waitcnt lgkmcnt(10)
    v_mfma_f32_32x32x16_bf16 v[80:95], v[48:51], v[208:211], v[80:95]
    ds_read_b64_tr_b16 v[40:41], v5 offset:25600
    ds_read_b64_tr_b16 v[42:43], v5 offset:25856
    s_add_u32 s68, s66, 327680
    s_add_u32 m0, s67, 8192
    s_nop 0
    buffer_load_dwordx4 v2, s[52:55], s68 offen lds
    s_waitcnt lgkmcnt(10)
    v_mfma_f32_32x32x16_bf16 v[80:95], v[52:55], v[212:215], v[80:95]
    ds_read_b64_tr_b16 v[44:45], v5 offset:26112
    ds_read_b64_tr_b16 v[46:47], v5 offset:26368
    s_waitcnt lgkmcnt(10)
    v_mfma_f32_32x32x16_bf16 v[80:95], v[56:59], v[216:219], v[80:95]
    ds_read_b64_tr_b16 v[48:49], v5 offset:28672
    ds_read_b64_tr_b16 v[50:51], v5 offset:28928
    s_add_u32 s68, s66, 360448
    s_add_u32 m0, s67, 12288
    s_nop 0
    buffer_load_dwordx4 v2, s[52:55], s68 offen lds
    s_waitcnt lgkmcnt(10)
    v_mfma_f32_32x32x16_bf16 v[80:95], v[60:63], v[220:223], v[80:95]
    ds_read_b64_tr_b16 v[52:53], v5 offset:29184
    ds_read_b64_tr_b16 v[54:55], v5 offset:29440
    s_waitcnt lgkmcnt(10)
    v_mfma_f32_32x32x16_bf16 v[80:95], v[32:35], v[224:227], v[80:95]
    ds_read_b64_tr_b16 v[56:57], v5 offset:29696
    ds_read_b64_tr_b16 v[58:59], v5 offset:29952
    s_add_u32 s68, s66, 393216
    s_add_u32 m0, s67, 16384
    s_nop 0
    buffer_load_dwordx4 v2, s[52:55], s68 offen lds
    s_waitcnt lgkmcnt(10)
    v_mfma_f32_32x32x16_bf16 v[80:95], v[36:39], v[228:231], v[80:95]
    ds_read_b64_tr_b16 v[60:61], v5 offset:30208
    ds_read_b64_tr_b16 v[62:63], v5 offset:30464
    s_waitcnt lgkmcnt(10)
    v_mfma_f32_32x32x16_bf16 v[80:95], v[40:43], v[232:235], v[80:95]
    s_add_u32 s68, s66, 425984
    s_add_u32 m0, s67, 20480
    s_nop 0
    buffer_load_dwordx4 v2, s[52:55], s68 offen lds
    s_waitcnt lgkmcnt(8)
    v_mfma_f32_32x32x16_bf16 v[80:95], v[44:47], v[236:239], v[80:95]
    s_waitcnt lgkmcnt(6)
    v_mfma_f32_32x32x16_bf16 v[80:95], v[48:51], v[240:243], v[80:95]
    s_add_u32 s68, s66, 458752
    s_add_u32 m0, s67, 24576
    s_nop 0
    buffer_load_dwordx4 v2, s[52:55], s68 offen lds
    ds_read_b32 v8, v6 offset:36
    s_waitcnt lgkmcnt(5)
    v_mfma_f32_32x32x16_bf16 v[80:95], v[52:55], v[244:247], v[80:95]
    s_waitcnt lgkmcnt(3)
    v_mfma_f32_32x32x16_bf16 v[80:95], v[56:59], v[248:251], v[80:95]
    s_add_u32 s68, s66, 491520
    s_add_u32 m0, s67, 28672
    s_nop 0
    buffer_load_dwordx4 v2, s[52:55], s68 offen lds
    s_waitcnt lgkmcnt(1)
    v_mfma_f32_32x32x16_bf16 v[80:95], v[60:63], v[252:255], v[80:95]
    s_mul_i32 s60, s38, 36864
    s_add_u32 s60, s60, 6356992
    v_mov_b32 v108, 0
    v_mov_b32 v109, 0
    v_mov_b32 v110, 0
    v_mov_b32 v111, 0
    s_nop 5
    v_cvt_pk_bf16_f32 v32, v80, v81
    v_cvt_pk_bf16_f32 v33, v82, v83
    v_cvt_pk_bf16_f32 v34, v84, v85
    v_cvt_pk_bf16_f32 v35, v86, v87
    v_cvt_pk_bf16_f32 v36, v88, v89
    v_cvt_pk_bf16_f32 v37, v90, v91
    v_cvt_pk_bf16_f32 v38, v92, v93
    v_cvt_pk_bf16_f32 v39, v94, v95
    v_mfma_f32_32x32x16_bf16 v[64:79], v[96:99], v[32:35], 0
    s_nop 0
    v_mfma_f32_32x32x16_bf16 v[64:79], v[100:103], v[36:39], v[64:79]
    s_nop 11
    v_max3_f32 v16, v64, v65, v66
    v_max3_f32 v17, v72, v73, v74
    v_min3_f32 v18, v64, v65, v66
    v_min3_f32 v19, v72, v73, v74
    v_max3_f32 v16, v16, v67, v68
    v_max3_f32 v17, v17, v75, v76
    v_min3_f32 v18, v18, v67, v68
    v_min3_f32 v19, v19, v75, v76
    v_max3_f32 v16, v16, v69, v70
    v_max3_f32 v17, v17, v77, v78
    v_min3_f32 v18, v18, v69, v70
    v_min3_f32 v19, v19, v77, v78
    v_max_f32 v16, v16, v71
    v_max_f32 v17, v17, v79
    v_min_f32 v18, v18, v71
    v_min_f32 v19, v19, v79
    v_permlane32_swap_b32 v16, v17
    s_nop 0
    v_permlane32_swap_b32 v18, v19
    v_max_f32 v20, v16, v17
    v_min_f32 v22, v18, v19
    v_mul_f32 v21, s62, v20
    v_mul_f32 v23, s62, v22
    v_mul_f32 v20, s62, v20
    v_mul_f32 v22, s62, v22
    s_nop 0
    v_permlane32_swap_b32 v20, v21
    v_permlane32_swap_b32 v22, v23
    v_fma_f32 v32, v64, s62, -v20
    v_fma_f32 v40, v72, s62, -v21
    v_fma_f32 v48, -v64, s62, v22
    v_exp_f32 v32, v32
    v_fma_f32 v56, -v72, s62, v23
    v_exp_f32 v40, v40
    v_fma_f32 v33, v65, s62, -v20
    v_exp_f32 v48, v48
    v_fma_f32 v41, v73, s62, -v21
    v_exp_f32 v56, v56
    v_fma_f32 v49, -v65, s62, v22
    v_exp_f32 v33, v33
    v_fma_f32 v57, -v73, s62, v23
    v_exp_f32 v41, v41
    s_waitcnt lgkmcnt(0)
    v_readfirstlane_b32 s78, v8
    s_nop 0
    s_cmp_ge_u32 s78, 1
    s_cbranch_scc1 L_wd_16
    s_mov_b32 s79, 0
L_w_15:
    ds_read_b32 v8, v6 offset:36
    s_waitcnt lgkmcnt(0)
    v_readfirstlane_b32 s78, v8
    s_nop 0
    s_cmp_ge_u32 s78, 1
    s_cbranch_scc1 L_wd_16
    s_add_u32 s79, s79, 1
    s_cmp_lt_u32 s79, 200000
    s_cbranch_scc1 L_w_15
L_wd_16:
    s_add_u32 s68, s60, 0
    buffer_load_dwordx4 v[128:131], v13, s[40:43], s68 offen sc1
    s_add_u32 s68, s60, 4608
    buffer_load_dwordx4 v[132:135], v13, s[40:43], s68 offen sc1
    s_add_u32 s68, s60, 9216
    buffer_load_dwordx4 v[136:139], v13, s[40:43], s68 offen sc1
    s_add_u32 s68, s60, 13824
    buffer_load_dwordx4 v[140:143], v13, s[40:43], s68 offen sc1
    s_add_u32 s68, s60, 18432
    buffer_load_dwordx4 v[144:147], v13, s[40:43], s68 offen sc1
    s_add_u32 s68, s60, 23040
    buffer_load_dwordx4 v[148:151], v13, s[40:43], s68 offen sc1
    s_add_u32 s68, s60, 27648
    buffer_load_dwordx4 v[152:155], v13, s[40:43], s68 offen sc1
    s_add_u32 s68, s60, 32256
    buffer_load_dwordx4 v[156:159], v13, s[40:43], s68 offen sc1
    buffer_load_dwordx4 v[160:163], v15, s[40:43], s60 offen sc1
    v_fma_f32 v34, v66, s62, -v20
    v_exp_f32 v49, v49
    v_add_f32 v24, v32, v33
    v_fma_f32 v42, v74, s62, -v21
    v_exp_f32 v57, v57
    v_add_f32 v25, v40, v41
    v_fma_f32 v50, -v66, s62, v22
    v_exp_f32 v34, v34
    v_add_f32 v26, v48, v49
    v_fma_f32 v58, -v74, s62, v23
    v_exp_f32 v42, v42
    v_add_f32 v27, v56, v57
    v_fma_f32 v35, v67, s62, -v20
    v_exp_f32 v50, v50
    v_add_f32 v24, v24, v34
    v_fma_f32 v43, v75, s62, -v21
    v_exp_f32 v58, v58
    v_add_f32 v25, v25, v42
    v_fma_f32 v51, -v67, s62, v22
    v_exp_f32 v35, v35
    v_add_f32 v26, v26, v50
    v_fma_f32 v59, -v75, s62, v23
    v_exp_f32 v43, v43
    v_add_f32 v27, v27, v58
    v_fma_f32 v36, v68, s62, -v20
    v_exp_f32 v51, v51
    v_add_f32 v24, v24, v35
    v_fma_f32 v44, v76, s62, -v21
    v_exp_f32 v59, v59
    v_add_f32 v25, v25, v43
    v_fma_f32 v52, -v68, s62, v22
    v_exp_f32 v36, v36
    v_add_f32 v26, v26, v51
    v_fma_f32 v60, -v76, s62, v23
    v_exp_f32 v44, v44
    v_add_f32 v27, v27, v59
    v_fma_f32 v37, v69, s62, -v20
    v_exp_f32 v52, v52
    v_add_f32 v24, v24, v36
    v_fma_f32 v45, v77, s62, -v21
    v_exp_f32 v60, v60
    v_add_f32 v25, v25, v44
    v_fma_f32 v53, -v69, s62, v22
    v_exp_f32 v37, v37
    v_add_f32 v26, v26, v52
    v_fma_f32 v61, -v77, s62, v23
    v_exp_f32 v45, v45
    v_add_f32 v27, v27, v60
    v_fma_f32 v38, v70, s62, -v20
    v_exp_f32 v53, v53
    v_add_f32 v24, v24, v37
    v_fma_f32 v46, v78, s62, -v21
    v_exp_f32 v61, v61
    v_add_f32 v25, v25, v45
    v_fma_f32 v54, -v70, s62, v22
    v_exp_f32 v38, v38
    v_add_f32 v26, v26, v53
    v_fma_f32 v62, -v78, s62, v23
    v_exp_f32 v46, v46
    v_add_f32 v27, v27, v61
    v_fma_f32 v39, v71, s62, -v20
    v_exp_f32 v54, v54
    v_add_f32 v24, v24, v38
    v_fma_f32 v47, v79, s62, -v21
    v_exp_f32 v62, v62
    v_add_f32 v25, v25, v46
    v_fma_f32 v55, -v71, s62, v22
    v_exp_f32 v39, v39
    v_add_f32 v26, v26, v54
    v_fma_f32 v63, -v79, s62, v23
    v_exp_f32 v47, v47
    v_add_f32 v27, v27, v62
    v_exp_f32 v55, v55
    v_add_f32 v24, v24, v39
    v_exp_f32 v63, v63
    v_add_f32 v25, v25, v47
    v_add_f32 v26, v26, v55
    v_add_f32 v27, v27, v63
    v_permlane32_swap_b32 v24, v25
    s_nop 0
    v_permlane32_swap_b32 v26, v27
    v_add_f32 v16, v24, v25
    v_add_f32 v18, v26, v27
    v_rcp_f32 v16, v16
    v_rcp_f32 v18, v18
    v_mov_b32 v17, v16
    v_mov_b32 v19, v18
    s_nop 0
    v_permlane32_swap_b32 v16, v17
    v_permlane32_swap_b32 v18, v19
    v_mul_f32 v32, v32, v16
    v_mul_f32 v33, v33, v16
    v_mul_f32 v34, v34, v16
    v_mul_f32 v35, v35, v16
    v_mul_f32 v36, v36, v16
    v_mul_f32 v37, v37, v16
    v_mul_f32 v38, v38, v16
    v_mul_f32 v39, v39, v16
    v_cvt_pk_bf16_f32 v64, v32, v33
    v_cvt_pk_bf16_f32 v65, v34, v35
    v_cvt_pk_bf16_f32 v66, v36, v37
    v_cvt_pk_bf16_f32 v67, v38, v39
    v_mul_f32 v48, v48, v18
    v_mul_f32 v49, v49, v18
    v_mul_f32 v50, v50, v18
    v_mul_f32 v51, v51, v18
    v_mul_f32 v52, v52, v18
    v_mul_f32 v53, v53, v18
    v_mul_f32 v54, v54, v18
    v_mul_f32 v55, v55, v18
    v_cvt_pk_bf16_f32 v68, v48, v49
    v_cvt_pk_bf16_f32 v69, v50, v51
    v_cvt_pk_bf16_f32 v70, v52, v53
    v_cvt_pk_bf16_f32 v71, v54, v55
    v_mul_f32 v40, v40, v17
    v_mul_f32 v41, v41, v17
    v_mul_f32 v42, v42, v17
    v_mul_f32 v43, v43, v17
    v_mul_f32 v44, v44, v17
    v_mul_f32 v45, v45, v17
    v_mul_f32 v46, v46, v17
    v_mul_f32 v47, v47, v17
    v_cvt_pk_bf16_f32 v72, v40, v41
    v_cvt_pk_bf16_f32 v73, v42, v43
    v_cvt_pk_bf16_f32 v74, v44, v45
    v_cvt_pk_bf16_f32 v75, v46, v47
    v_mul_f32 v56, v56, v19
    v_mul_f32 v57, v57, v19
    v_mul_f32 v58, v58, v19
    v_mul_f32 v59, v59, v19
    v_mul_f32 v60, v60, v19
    v_mul_f32 v61, v61, v19
    v_mul_f32 v62, v62, v19
    v_mul_f32 v63, v63, v19
    v_cvt_pk_bf16_f32 v76, v56, v57
    v_cvt_pk_bf16_f32 v77, v58, v59
    v_cvt_pk_bf16_f32 v78, v60, v61
    v_cvt_pk_bf16_f32 v79, v62, v63
    v_and_b32 v16, 15, v1
    v_lshrrev_b32 v18, 4, v1
    v_lshlrev_b32 v16, 5, v16
    v_lshl_add_u32 v16, v18, 3, v16
    s_lshl_b32 s61, s39, 12
    s_add_u32 s61, s61, 98304
    v_add_u32 v16, s61, v16
    v_and_b32 v17, 31, v1
    v_lshrrev_b32 v18, 5, v1
    v_lshlrev_b32 v17, 5, v17
    v_lshl_add_u32 v17, v18, 4, v17
    v_add_u32 v17, 98304, v17
    s_mov_b32 s77, 0
    s_waitcnt vmcnt(8)
    v_max3_u32 v24, v128, v129, v130
    v_max_u32 v24, v24, v131
    v_cmp_eq_u32 vcc, -1, v24
    s_bitset1_b32 s77, 0
    s_nop 0
    s_cbranch_vccnz L_pgs_19
    s_bitset0_b32 s77, 0
    v_mfma_f32_16x16x32_bf16 v[108:111], v[104:107], v[128:131], v[108:111]
L_pgs_19:
    s_waitcnt vmcnt(7)
    v_max3_u32 v24, v132, v133, v134
    v_max_u32 v24, v24, v135
    v_cmp_eq_u32 vcc, -1, v24
    s_bitset1_b32 s77, 1
    s_nop 0
    s_cbranch_vccnz L_pgs_20
    s_bitset0_b32 s77, 1
    v_mfma_f32_16x16x32_bf16 v[108:111], v[104:107], v[132:135], v[108:111]
L_pgs_20:
    s_waitcnt vmcnt(6)
    v_max3_u32 v24, v136, v137, v138
    v_max_u32 v24, v24, v139
    v_cmp_eq_u32 vcc, -1, v24
    s_bitset1_b32 s77, 2
    s_nop 0
    s_cbranch_vccnz L_pgs_21
    s_bitset0_b32 s77, 2
    v_mfma_f32_16x16x32_bf16 v[108:111], v[104:107], v[136:139], v[108:111]
L_pgs_21:
    s_waitcnt vmcnt(5)
    v_max3_u32 v24, v140, v141, v142
    v_max_u32 v24, v24, v143
    v_cmp_eq_u32 vcc, -1, v24
    s_bitset1_b32 s77, 3
    s_nop 0
    s_cbranch_vccnz L_pgs_22
    s_bitset0_b32 s77, 3
    v_mfma_f32_16x16x32_bf16 v[108:111], v[104:107], v[140:143], v[108:111]
L_pgs_22:
    s_waitcnt vmcnt(4)
    v_max3_u32 v24, v144, v145, v146
    v_max_u32 v24, v24, v147
    v_cmp_eq_u32 vcc, -1, v24
    s_bitset1_b32 s77, 4
    s_nop 0
    s_cbranch_vccnz L_pgs_23
    s_bitset0_b32 s77, 4
    v_mfma_f32_16x16x32_bf16 v[108:111], v[104:107], v[144:147], v[108:111]
L_pgs_23:
    s_waitcnt vmcnt(3)
    v_max3_u32 v24, v148, v149, v150
    v_max_u32 v24, v24, v151
    v_cmp_eq_u32 vcc, -1, v24
    s_bitset1_b32 s77, 5
    s_nop 0
    s_cbranch_vccnz L_pgs_24
    s_bitset0_b32 s77, 5
    v_mfma_f32_16x16x32_bf16 v[108:111], v[104:107], v[148:151], v[108:111]
L_pgs_24:
    s_waitcnt vmcnt(2)
    v_max3_u32 v24, v152, v153, v154
    v_max_u32 v24, v24, v155
    v_cmp_eq_u32 vcc, -1, v24
    s_bitset1_b32 s77, 6
    s_nop 0
    s_cbranch_vccnz L_pgs_25
    s_bitset0_b32 s77, 6
    v_mfma_f32_16x16x32_bf16 v[108:111], v[104:107], v[152:155], v[108:111]
L_pgs_25:
    s_waitcnt vmcnt(1)
    v_max3_u32 v24, v156, v157, v158
    v_max_u32 v24, v24, v159
    v_cmp_eq_u32 vcc, -1, v24
    s_bitset1_b32 s77, 7
    s_nop 0
    s_cbranch_vccnz L_pgs_26
    s_bitset0_b32 s77, 7
    v_mfma_f32_16x16x32_bf16 v[108:111], v[104:107], v[156:159], v[108:111]
L_pgs_26:
    s_waitcnt vmcnt(0)
    v_max3_u32 v24, v160, v161, v162
    v_max_u32 v24, v24, v163
    v_cmp_eq_u32 vcc, -1, v24
    s_bitset1_b32 s77, 8
    s_nop 0
    s_cbranch_vccnz L_pgs_27
    s_bitset0_b32 s77, 8
L_pgs_27:
    s_cmp_eq_u32 s77, 0
    s_cbranch_scc0 L_pge_28
L_pgd_17:
    s_nop 7
    v_add_f32_dpp v160, v160, v160 row_ror:8 row_mask:0xf bank_mask:0xf
    v_add_f32_dpp v161, v161, v161 row_ror:8 row_mask:0xf bank_mask:0xf
    v_add_f32_dpp v162, v162, v162 row_ror:8 row_mask:0xf bank_mask:0xf
    v_add_f32_dpp v163, v163, v163 row_ror:8 row_mask:0xf bank_mask:0xf
    v_add_f32_dpp v160, v160, v160 row_ror:4 row_mask:0xf bank_mask:0xf
    v_add_f32_dpp v161, v161, v161 row_ror:4 row_mask:0xf bank_mask:0xf
    v_add_f32_dpp v162, v162, v162 row_ror:4 row_mask:0xf bank_mask:0xf
    v_add_f32_dpp v163, v163, v163 row_ror:4 row_mask:0xf bank_mask:0xf
    v_cvt_pk_bf16_f32 v20, v108, v109
    v_cvt_pk_bf16_f32 v21, v110, v111
    ds_write_b64 v16, v[20:21]
    v_add_f32_dpp v160, v160, v160 row_ror:2 row_mask:0xf bank_mask:0xf
    v_add_f32_dpp v161, v161, v161 row_ror:2 row_mask:0xf bank_mask:0xf
    v_add_f32_dpp v162, v162, v162 row_ror:2 row_mask:0xf bank_mask:0xf
    v_add_f32_dpp v163, v163, v163 row_ror:2 row_mask:0xf bank_mask:0xf
    v_add_f32_dpp v160, v160, v160 row_ror:1 row_mask:0xf bank_mask:0xf
    v_add_f32_dpp v161, v161, v161 row_ror:1 row_mask:0xf bank_mask:0xf
    v_add_f32_dpp v162, v162, v162 row_ror:1 row_mask:0xf bank_mask:0xf
    v_add_f32_dpp v163, v163, v163 row_ror:1 row_mask:0xf bank_mask:0xf
    v_cvt_pk_bf16_f32 v22, v160, v161
    v_cvt_pk_bf16_f32 v23, v162, v163
    ds_write_b64 v16, v[22:23] offset:512
    v_mov_b32 v12, 11
    s_mov_b64 exec, 1
    ds_write_b32 v7, v12
    s_mov_b64 exec, -1
    s_lshl_b32 s60, s37, 2
    s_add_u32 s60, s60, s39
    s_lshl_b32 s60, s60, 4
    s_add_u32 s60, s60, s38
    s_lshl_b32 s60, s60, 11
    s_add_u32 s60, s60, 4259840
    v_lshlrev_b32 v15, 4, v1
    s_mov_b32 s61, 0x358637bd
    s_mov_b32 s79, 0
L_w_47:
    ds_read_b128 v[8:11], v6 offset:0
    s_waitcnt lgkmcnt(0)
    v_min3_u32 v8, v8, v9, v10
    v_min_u32 v8, v8, v11
    s_nop 0
    v_readfirstlane_b32 s78, v8
    s_nop 0
    s_cmp_ge_u32 s78, 11
    s_cbranch_scc1 L_wd_48
    s_add_u32 s79, s79, 1
    s_cmp_lt_u32 s79, 200000
    s_cbranch_scc1 L_w_47
L_wd_48:
    ds_read_b128 v[32:35], v17 offset:0
    ds_read_b128 v[36:39], v17 offset:4096
    ds_read_b128 v[40:43], v17 offset:8192
    ds_read_b128 v[44:47], v17 offset:12288
    ds_read_b32 v8, v6 offset:40
    s_waitcnt lgkmcnt(3)
    v_mfma_f32_32x32x16_bf16 v[48:63], v[32:35], v[64:67], 0
    v_mfma_f32_32x32x16_bf16 v[48:63], v[36:39], v[68:71], v[48:63]
    s_waitcnt lgkmcnt(1)
    v_mfma_f32_32x32x16_bf16 v[80:95], v[40:43], v[72:75], 0
    v_mfma_f32_32x32x16_bf16 v[80:95], v[44:47], v[76:79], v[80:95]
    v_lshrrev_b32 v16, 5, v1
    v_bfe_u32 v17, v1, 2, 2
    v_lshl_add_u32 v16, v16, 3, v17
    v_lshlrev_b32 v16, 7, v16
    v_bfe_u32 v17, v1, 3, 1
    v_lshl_add_u32 v16, v17, 6, v16
    v_bfe_u32 v17, v1, 4, 1
    v_lshl_add_u32 v16, v17, 5, v16
    v_and_b32 v17, 3, v1
    v_lshl_add_u32 v16, v17, 3, v16
    s_lshl_b32 s64, s37, 2
    s_and_b32 s68, s38, 1
    s_lshl_b32 s68, s68, 1
    s_add_u32 s64, s64, s68
    s_and_b32 s68, s39, 1
    s_add_u32 s65, s64, s68
    s_lshr_b32 s68, s39, 1
    s_lshl_b32 s64, s65, 1
    s_add_u32 s64, s64, s68
    s_lshl_b32 s64, s64, 14
    s_add_u32 s64, s64, 4259840
    v_lshlrev_b32 v26, 11, v1
    s_mov_b32 s72, 0
    s_mov_b32 s73, 0x80000000
    s_waitcnt lgkmcnt(0)
    v_readfirstlane_b32 s78, v8
    s_nop 0
    s_cmp_ge_u32 s78, 1
    s_cbranch_scc1 L_wd_50
    s_mov_b32 s79, 0
L_w_49:
    ds_read_b32 v8, v6 offset:40
    s_waitcnt lgkmcnt(0)
    v_readfirstlane_b32 s78, v8
    s_nop 0
    s_cmp_ge_u32 s78, 1
    s_cbranch_scc1 L_wd_50
    s_add_u32 s79, s79, 1
    s_cmp_lt_u32 s79, 200000
    s_cbranch_scc1 L_w_49
L_wd_50:
    v_add_f32 v20, s61, v56
    v_rcp_f32 v20, v20
    s_nop 0
    v_mul_f32 v48, v48, v20
    v_mul_f32 v49, v49, v20
    v_mul_f32 v50, v50, v20
    v_mul_f32 v51, v51, v20
    v_mul_f32 v52, v52, v20
    v_mul_f32 v53, v53, v20
    v_mul_f32 v54, v54, v20
    v_mul_f32 v55, v55, v20
    v_cvt_pk_bf16_f32 v96, v48, v49
    v_cvt_pk_bf16_f32 v97, v50, v51
    v_cvt_pk_bf16_f32 v98, v52, v53
    v_cvt_pk_bf16_f32 v99, v54, v55
    v_min_u32 v96, -2, v96
    v_min_u32 v97, -2, v97
    v_min_u32 v98, -2, v98
    v_min_u32 v99, -2, v99
    buffer_store_dwordx4 v[96:99], v15, s[40:43], s60 offen offset:0 sc1
    v_add_f32 v21, s61, v88
    v_rcp_f32 v21, v21
    s_nop 0
    v_mul_f32 v80, v80, v21
    v_mul_f32 v81, v81, v21
    v_mul_f32 v82, v82, v21
    v_mul_f32 v83, v83, v21
    v_mul_f32 v84, v84, v21
    v_mul_f32 v85, v85, v21
    v_mul_f32 v86, v86, v21
    v_mul_f32 v87, v87, v21
    v_cvt_pk_bf16_f32 v100, v80, v81
    v_cvt_pk_bf16_f32 v101, v82, v83
    v_cvt_pk_bf16_f32 v102, v84, v85
    v_cvt_pk_bf16_f32 v103, v86, v87
    v_min_u32 v100, -2, v100
    v_min_u32 v101, -2, v101
    v_min_u32 v102, -2, v102
    v_min_u32 v103, -2, v103
    buffer_store_dwordx4 v[100:103], v15, s[40:43], s60 offen offset:1024 sc1
    s_lshr_b32 s61, s39, 1
    s_xor_b32 s60, s61, 1
    s_lshl_b32 s60, s60, 15
    v_add_u32 v16, s60, v16
    v_xor_b32 v17, 64, v16
    ds_read_b64_tr_b16 v[128:129], v16 offset:0
    ds_read_b64_tr_b16 v[130:131], v16 offset:512
    ds_read_b64_tr_b16 v[132:133], v17 offset:0
    ds_read_b64_tr_b16 v[134:135], v17 offset:512
    ds_read_b64_tr_b16 v[136:137], v16 offset:2048
    ds_read_b64_tr_b16 v[138:139], v16 offset:2560
    ds_read_b64_tr_b16 v[140:141], v17 offset:2048
    ds_read_b64_tr_b16 v[142:143], v17 offset:2560
    ds_read_b64_tr_b16 v[144:145], v16 offset:4096
    ds_read_b64_tr_b16 v[146:147], v16 offset:4608
    ds_read_b64_tr_b16 v[148:149], v17 offset:4096
    ds_read_b64_tr_b16 v[150:151], v17 offset:4608
    ds_read_b64_tr_b16 v[152:153], v16 offset:6144
    ds_read_b64_tr_b16 v[154:155], v16 offset:6656
    ds_read_b64_tr_b16 v[156:157], v17 offset:6144
    ds_read_b64_tr_b16 v[158:159], v17 offset:6656
    ds_read_b64_tr_b16 v[160:161], v16 offset:8192
    ds_read_b64_tr_b16 v[162:163], v16 offset:8704
    ds_read_b64_tr_b16 v[164:165], v17 offset:8192
    ds_read_b64_tr_b16 v[166:167], v17 offset:8704
    ds_read_b64_tr_b16 v[168:169], v16 offset:10240
    ds_read_b64_tr_b16 v[170:171], v16 offset:10752
    ds_read_b64_tr_b16 v[172:173], v17 offset:10240
    ds_read_b64_tr_b16 v[174:175], v17 offset:10752
    ds_read_b64_tr_b16 v[176:177], v16 offset:12288
    ds_read_b64_tr_b16 v[178:179], v16 offset:12800
    ds_read_b64_tr_b16 v[180:181], v17 offset:12288
    ds_read_b64_tr_b16 v[182:183], v17 offset:12800
    ds_read_b64_tr_b16 v[184:185], v16 offset:14336
    ds_read_b64_tr_b16 v[186:187], v16 offset:14848
    ds_read_b64_tr_b16 v[188:189], v17 offset:14336
    ds_read_b64_tr_b16 v[190:191], v17 offset:14848
    ds_read_b64_tr_b16 v[192:193], v16 offset:16384
    ds_read_b64_tr_b16 v[194:195], v16 offset:16896
    ds_read_b64_tr_b16 v[196:197], v17 offset:16384
    ds_read_b64_tr_b16 v[198:199], v17 offset:16896
    ds_read_b64_tr_b16 v[200:201], v16 offset:18432
    ds_read_b64_tr_b16 v[202:203], v16 offset:18944
    ds_read_b64_tr_b16 v[204:205], v17 offset:18432
    ds_read_b64_tr_b16 v[206:207], v17 offset:18944
    ds_read_b64_tr_b16 v[208:209], v16 offset:20480
    ds_read_b64_tr_b16 v[210:211], v16 offset:20992
    ds_read_b64_tr_b16 v[212:213], v17 offset:20480
    ds_read_b64_tr_b16 v[214:215], v17 offset:20992
    ds_read_b64_tr_b16 v[216:217], v16 offset:22528
    ds_read_b64_tr_b16 v[218:219], v16 offset:23040
    ds_read_b64_tr_b16 v[220:221], v17 offset:22528
    ds_read_b64_tr_b16 v[222:223], v17 offset:23040
    ds_read_b64_tr_b16 v[224:225], v16 offset:24576
    ds_read_b64_tr_b16 v[226:227], v16 offset:25088
    ds_read_b64_tr_b16 v[228:229], v17 offset:24576
    ds_read_b64_tr_b16 v[230:231], v17 offset:25088
    ds_read_b64_tr_b16 v[232:233], v16 offset:26624
    ds_read_b64_tr_b16 v[234:235], v16 offset:27136
    ds_read_b64_tr_b16 v[236:237], v17 offset:26624
    ds_read_b64_tr_b16 v[238:239], v17 offset:27136
    ds_read_b64_tr_b16 v[240:241], v16 offset:28672
    ds_read_b64_tr_b16 v[242:243], v16 offset:29184
    ds_read_b64_tr_b16 v[244:245], v17 offset:28672
    ds_read_b64_tr_b16 v[246:247], v17 offset:29184
    ds_read_b64_tr_b16 v[248:249], v16 offset:30720
    ds_read_b64_tr_b16 v[250:251], v16 offset:31232
    ds_read_b64_tr_b16 v[252:253], v17 offset:30720
    ds_read_b64_tr_b16 v[254:255], v17 offset:31232
    s_mov_b32 s60, s64
    s_mov_b32 s70, s65
    v_mov_b32 v96, 0
    v_mov_b32 v97, 0
    v_mov_b32 v98, 0
    v_mov_b32 v99, 0
    v_mov_b32 v100, 0
    v_mov_b32 v101, 0
    v_mov_b32 v102, 0
    v_mov_b32 v103, 0
    v_mov_b32 v104, 0
    v_mov_b32 v105, 0
    v_mov_b32 v106, 0
    v_mov_b32 v107, 0
    v_mov_b32 v108, 0
    v_mov_b32 v109, 0
    v_mov_b32 v110, 0
    v_mov_b32 v111, 0
    v_mov_b32 v112, 0
    v_mov_b32 v113, 0
    v_mov_b32 v114, 0
    v_mov_b32 v115, 0
    v_mov_b32 v116, 0
    v_mov_b32 v117, 0
    v_mov_b32 v118, 0
    v_mov_b32 v119, 0
    v_mov_b32 v120, 0
    v_mov_b32 v121, 0
    v_mov_b32 v122, 0
    v_mov_b32 v123, 0
    v_mov_b32 v124, 0
    v_mov_b32 v125, 0
    v_mov_b32 v126, 0
    v_mov_b32 v127, 0
    s_lshl_b32 s71, s39, 12
    s_add_u32 s71, s71, 65536
    v_add_u32 v16, s71, v15
    s_xor_b32 s71, s71, 8192
    v_add_u32 v17, s71, v15
    v_xor_b32 v18, 8, v7
    s_lshl_b32 s70, s70, 16
    s_lshr_b32 s69, s38, 1
    s_lshl_b32 s69, s69, 7
    s_add_u32 s70, s70, s69
    s_lshl_b32 s69, s61, 6
    s_add_u32 s70, s70, s69
    v_and_b32 v19, 31, v1
    v_lshrrev_b32 v20, 5, v1
    v_lshlrev_b32 v19, 11, v19
    v_lshl_add_u32 v19, v20, 4, v19
    s_mov_b32 s56, s30
    s_mov_b32 s57, s31
    s_mov_b32 s58, 0x400000
    s_mov_b32 s59, 0x00020000
    s_waitcnt lgkmcnt(0)
    s_add_u32 s68, s60, 0
    buffer_load_dwordx4 v[32:35], v15, s[40:43], s68 offen offset:0 sc1
    buffer_load_dwordx4 v[36:39], v15, s[40:43], s68 offen offset:1024 sc1
    s_add_u32 s68, s60, 0
    buffer_load_dwordx4 v[40:43], v15, s[40:43], s68 offen offset:2048 sc1
    buffer_load_dwordx4 v[44:47], v15, s[40:43], s68 offen offset:3072 sc1
    s_add_u32 s68, s60, 4096
    buffer_load_dwordx4 v[48:51], v15, s[40:43], s68 offen offset:0 sc1
    buffer_load_dwordx4 v[52:55], v15, s[40:43], s68 offen offset:1024 sc1
    s_add_u32 s68, s60, 4096
    buffer_load_dwordx4 v[56:59], v15, s[40:43], s68 offen offset:2048 sc1
    buffer_load_dwordx4 v[60:63], v15, s[40:43], s68 offen offset:3072 sc1
    s_add_u32 s68, s60, 8192
    buffer_load_dwordx4 v[64:67], v15, s[40:43], s68 offen offset:0 sc1
    buffer_load_dwordx4 v[68:71], v15, s[40:43], s68 offen offset:1024 sc1
    s_add_u32 s68, s60, 8192
    buffer_load_dwordx4 v[72:75], v15, s[40:43], s68 offen offset:2048 sc1
    buffer_load_dwordx4 v[76:79], v15, s[40:43], s68 offen offset:3072 sc1
    s_add_u32 s68, s60, 12288
    buffer_load_dwordx4 v[80:83], v15, s[40:43], s68 offen offset:0 sc1
    buffer_load_dwordx4 v[84:87], v15, s[40:43], s68 offen offset:1024 sc1
    s_add_u32 s68, s60, 12288
    buffer_load_dwordx4 v[88:91], v15, s[40:43], s68 offen offset:2048 sc1
    buffer_load_dwordx4 v[92:95], v15, s[40:43], s68 offen offset:3072 sc1
    s_mov_b32 s77, 0
    s_waitcnt vmcnt(14)
    v_max3_u32 v24, v32, v33, v34
    v_max3_u32 v24, v24, v35, v36
    v_max3_u32 v24, v24, v37, v38
    v_max_u32 v24, v24, v39
    v_cmp_eq_u32 vcc, -1, v24
    s_bitset1_b32 s77, 0
    s_nop 0
    s_cbranch_vccnz L_pgs_53
    s_bitset0_b32 s77, 0
    v_mfma_f32_32x32x16_bf16 v[96:111], v[128:131], v[32:35], v[96:111]
    v_mfma_f32_32x32x16_bf16 v[112:127], v[132:135], v[32:35], v[112:127]
    v_mfma_f32_32x32x16_bf16 v[96:111], v[136:139], v[36:39], v[96:111]
    v_mfma_f32_32x32x16_bf16 v[112:127], v[140:143], v[36:39], v[112:127]
L_pgs_53:
    s_waitcnt vmcnt(12)
    v_max3_u32 v24, v40, v41, v42
    v_max3_u32 v24, v24, v43, v44
    v_max3_u32 v24, v24, v45, v46
    v_max_u32 v24, v24, v47
    v_cmp_eq_u32 vcc, -1, v24
    s_bitset1_b32 s77, 1
    s_nop 0
    s_cbranch_vccnz L_pgs_54
    s_bitset0_b32 s77, 1
    v_mfma_f32_32x32x16_bf16 v[96:111], v[144:147], v[40:43], v[96:111]
    v_mfma_f32_32x32x16_bf16 v[112:127], v[148:151], v[40:43], v[112:127]
    v_mfma_f32_32x32x16_bf16 v[96:111], v[152:155], v[44:47], v[96:111]
    v_mfma_f32_32x32x16_bf16 v[112:127], v[156:159], v[44:47], v[112:127]
L_pgs_54:
    s_waitcnt vmcnt(10)
    v_max3_u32 v24, v48, v49, v50
    v_max3_u32 v24, v24, v51, v52
    v_max3_u32 v24, v24, v53, v54
    v_max_u32 v24, v24, v55
    v_cmp_eq_u32 vcc, -1, v24
    s_bitset1_b32 s77, 2
    s_nop 0
    s_cbranch_vccnz L_pgs_55
    s_bitset0_b32 s77, 2
    v_mfma_f32_32x32x16_bf16 v[96:111], v[160:163], v[48:51], v[96:111]
    v_mfma_f32_32x32x16_bf16 v[112:127], v[164:167], v[48:51], v[112:127]
    v_mfma_f32_32x32x16_bf16 v[96:111], v[168:171], v[52:55], v[96:111]
    v_mfma_f32_32x32x16_bf16 v[112:127], v[172:175], v[52:55], v[112:127]
L_pgs_55:
    s_waitcnt vmcnt(8)
    v_max3_u32 v24, v56, v57, v58
    v_max3_u32 v24, v24, v59, v60
    v_max3_u32 v24, v24, v61, v62
    v_max_u32 v24, v24, v63
    v_cmp_eq_u32 vcc, -1, v24
    s_bitset1_b32 s77, 3
    s_nop 0
    s_cbranch_vccnz L_pgs_56
    s_bitset0_b32 s77, 3
    v_mfma_f32_32x32x16_bf16 v[96:111], v[176:179], v[56:59], v[96:111]
    v_mfma_f32_32x32x16_bf16 v[112:127], v[180:183], v[56:59], v[112:127]
    v_mfma_f32_32x32x16_bf16 v[96:111], v[184:187], v[60:63], v[96:111]
    v_mfma_f32_32x32x16_bf16 v[112:127], v[188:191], v[60:63], v[112:127]
L_pgs_56:
    s_waitcnt vmcnt(6)
    v_max3_u32 v24, v64, v65, v66
    v_max3_u32 v24, v24, v67, v68
    v_max3_u32 v24, v24, v69, v70
    v_max_u32 v24, v24, v71
    v_cmp_eq_u32 vcc, -1, v24
    s_bitset1_b32 s77, 4
    s_nop 0
    s_cbranch_vccnz L_pgs_57
    s_bitset0_b32 s77, 4
    v_mfma_f32_32x32x16_bf16 v[96:111], v[192:195], v[64:67], v[96:111]
    v_mfma_f32_32x32x16_bf16 v[112:127], v[196:199], v[64:67], v[112:127]
    v_mfma_f32_32x32x16_bf16 v[96:111], v[200:203], v[68:71], v[96:111]
    v_mfma_f32_32x32x16_bf16 v[112:127], v[204:207], v[68:71], v[112:127]
L_pgs_57:
    s_waitcnt vmcnt(4)
    v_max3_u32 v24, v72, v73, v74
    v_max3_u32 v24, v24, v75, v76
    v_max3_u32 v24, v24, v77, v78
    v_max_u32 v24, v24, v79
    v_cmp_eq_u32 vcc, -1, v24
    s_bitset1_b32 s77, 5
    s_nop 0
    s_cbranch_vccnz L_pgs_58
    s_bitset0_b32 s77, 5
    v_mfma_f32_32x32x16_bf16 v[96:111], v[208:211], v[72:75], v[96:111]
    v_mfma_f32_32x32x16_bf16 v[112:127], v[212:215], v[72:75], v[112:127]
    v_mfma_f32_32x32x16_bf16 v[96:111], v[216:219], v[76:79], v[96:111]
    v_mfma_f32_32x32x16_bf16 v[112:127], v[220:223], v[76:79], v[112:127]
L_pgs_58:
    s_waitcnt vmcnt(2)
    v_max3_u32 v24, v80, v81, v82
    v_max3_u32 v24, v24, v83, v84
    v_max3_u32 v24, v24, v85, v86
    v_max_u32 v24, v24, v87
    v_cmp_eq_u32 vcc, -1, v24
    s_bitset1_b32 s77, 6
    s_nop 0
    s_cbranch_vccnz L_pgs_59
    s_bitset0_b32 s77, 6
    v_mfma_f32_32x32x16_bf16 v[96:111], v[224:227], v[80:83], v[96:111]
    v_mfma_f32_32x32x16_bf16 v[112:127], v[228:231], v[80:83], v[112:127]
    v_mfma_f32_32x32x16_bf16 v[96:111], v[232:235], v[84:87], v[96:111]
    v_mfma_f32_32x32x16_bf16 v[112:127], v[236:239], v[84:87], v[112:127]
L_pgs_59:
    s_waitcnt vmcnt(0)
    v_max3_u32 v24, v88, v89, v90
    v_max3_u32 v24, v24, v91, v92
    v_max3_u32 v24, v24, v93, v94
    v_max_u32 v24, v24, v95
    v_cmp_eq_u32 vcc, -1, v24
    s_bitset1_b32 s77, 7
    s_nop 0
    s_cbranch_vccnz L_pgs_60
    s_bitset0_b32 s77, 7
    v_mfma_f32_32x32x16_bf16 v[96:111], v[240:243], v[88:91], v[96:111]
    v_mfma_f32_32x32x16_bf16 v[112:127], v[244:247], v[88:91], v[112:127]
    v_mfma_f32_32x32x16_bf16 v[96:111], v[248:251], v[92:95], v[96:111]
    v_mfma_f32_32x32x16_bf16 v[112:127], v[252:255], v[92:95], v[112:127]
L_pgs_60:
    s_cmp_eq_u32 s77, 0
    s_cbranch_scc0 L_pge_61
L_pgd_51:
    s_nop 7
    s_cmp_eq_u32 s61, 1
    s_nop 11
    s_cbranch_scc1 L_kh1_78
    ds_write_b128 v16, v[112:115] offset:0
    ds_write_b128 v16, v[116:119] offset:1024
    ds_write_b128 v16, v[120:123] offset:2048
    ds_write_b128 v16, v[124:127] offset:3072
    v_mov_b32 v12, 12
    s_mov_b64 exec, 1
    ds_write_b32 v7, v12
    s_mov_b64 exec, -1
    s_mov_b32 s79, 0
L_w_80:
    ds_read_b32 v8, v18 offset:0
    s_waitcnt lgkmcnt(0)
    v_readfirstlane_b32 s78, v8
    s_nop 0
    s_cmp_ge_u32 s78, 12
    s_cbranch_scc1 L_wd_81
    s_add_u32 s79, s79, 1
    s_cmp_lt_u32 s79, 200000
    s_cbranch_scc1 L_w_80
L_wd_81:
    ds_read_b128 v[48:51], v17 offset:0
    ds_read_b128 v[52:55], v17 offset:1024
    ds_read_b128 v[56:59], v17 offset:2048
    ds_read_b128 v[60:63], v17 offset:3072
    s_waitcnt lgkmcnt(3)
    v_add_f32 v48, v48, v96
    v_add_f32 v49, v49, v97
    v_add_f32 v50, v50, v98
    v_add_f32 v51, v51, v99
    s_waitcnt lgkmcnt(2)
    v_add_f32 v52, v52, v100
    v_add_f32 v53, v53, v101
    v_add_f32 v54, v54, v102
    v_add_f32 v55, v55, v103
    s_waitcnt lgkmcnt(1)
    v_add_f32 v56, v56, v104
    v_add_f32 v57, v57, v105
    v_add_f32 v58, v58, v106
    v_add_f32 v59, v59, v107
    s_waitcnt lgkmcnt(0)
    v_add_f32 v60, v60, v108
    v_add_f32 v61, v61, v109
    v_add_f32 v62, v62, v110
    v_add_f32 v63, v63, v111
    s_branch L_khj_79
L_kh1_78:
    ds_write_b128 v16, v[96:99] offset:0
    ds_write_b128 v16, v[100:103] offset:1024
    ds_write_b128 v16, v[104:107] offset:2048
    ds_write_b128 v16, v[108:111] offset:3072
    v_mov_b32 v12, 12
    s_mov_b64 exec, 1
    ds_write_b32 v7, v12
    s_mov_b64 exec, -1
    s_mov_b32 s79, 0
L_w_82:
    ds_read_b32 v8, v18 offset:0
    s_waitcnt lgkmcnt(0)
    v_readfirstlane_b32 s78, v8
    s_nop 0
    s_cmp_ge_u32 s78, 12
    s_cbranch_scc1 L_wd_83
    s_add_u32 s79, s79, 1
    s_cmp_lt_u32 s79, 200000
    s_cbranch_scc1 L_w_82
L_wd_83:
    ds_read_b128 v[48:51], v17 offset:0
    ds_read_b128 v[52:55], v17 offset:1024
    ds_read_b128 v[56:59], v17 offset:2048
    ds_read_b128 v[60:63], v17 offset:3072
    s_waitcnt lgkmcnt(3)
    v_add_f32 v48, v48, v112
    v_add_f32 v49, v49, v113
    v_add_f32 v50, v50, v114
    v_add_f32 v51, v51, v115
    s_waitcnt lgkmcnt(2)
    v_add_f32 v52, v52, v116
    v_add_f32 v53, v53, v117
    v_add_f32 v54, v54, v118
    v_add_f32 v55, v55, v119
    s_waitcnt lgkmcnt(1)
    v_add_f32 v56, v56, v120
    v_add_f32 v57, v57, v121
    v_add_f32 v58, v58, v122
    v_add_f32 v59, v59, v123
    s_waitcnt lgkmcnt(0)
    v_add_f32 v60, v60, v124
    v_add_f32 v61, v61, v125
    v_add_f32 v62, v62, v126
    v_add_f32 v63, v63, v127
L_khj_79:
    v_cvt_pk_bf16_f32 v32, v48, v49
    v_cvt_pk_bf16_f32 v33, v50, v51
    v_cvt_pk_bf16_f32 v34, v52, v53
    v_cvt_pk_bf16_f32 v35, v54, v55
    v_cvt_pk_bf16_f32 v36, v56, v57
    v_cvt_pk_bf16_f32 v37, v58, v59
    v_cvt_pk_bf16_f32 v38, v60, v61
    v_cvt_pk_bf16_f32 v39, v62, v63
    v_permlane32_swap_b32 v32, v34
    v_permlane32_swap_b32 v33, v35
    v_permlane32_swap_b32 v36, v38
    v_permlane32_swap_b32 v37, v39
    buffer_store_dwordx4 v[32:35], v19, s[56:59], s70 offen offset:0
    buffer_store_dwordx4 v[36:39], v19, s[56:59], s70 offen offset:32
    s_waitcnt vmcnt(0)
    s_endpgm
L_roleB:
    s_setprio 3
    s_lshl_b32 s60, s37, 17
    s_lshl_b32 s61, s39, 15
    s_add_u32 s60, s60, s61
    s_lshl_b32 s61, s38, 6
    s_add_u32 s60, s60, s61
    s_add_u32 s44, s12, s60
    s_addc_u32 s45, s13, 0
    s_mov_b32 s46, 0x7c40
    s_mov_b32 s47, 0x00020000
    v_lshrrev_b32 v192, 2, v1
    v_and_b32 v193, 3, v1
    v_lshlrev_b32 v194, 10, v192
    v_lshl_add_u32 v194, v193, 4, v194
    s_lshl_b32 s68, s39, 11
    s_add_u32 s68, s68, 114688
    v_mov_b32 v248, v194
    s_mov_b32 m0, s68
    s_nop 0
    buffer_load_dwordx4 v248, s[44:47], 0 offen lds
    s_add_u32 m0, s68, 1024
    s_mov_b32 s60, 16384
    buffer_load_dwordx4 v248, s[44:47], s60 offen lds
    s_and_b32 s63, s39, 1
    s_lshr_b32 s64, s39, 1
    s_lshl_b32 s62, s38, 5
    s_lshl_b32 s60, s37, 1
    s_add_u32 s62, s62, s60
    s_lshl_b32 s60, s62, 1
    s_load_dword s66, s[26:27], s60
    s_mov_b32 s67, s62
    s_add_u32 s62, s62, s64
    s_mul_i32 s65, s64, 22272
    s_add_u32 s65, s65, 114688
    s_lshl_b32 s60, s62, 8
    s_lshl_b32 s61, s63, 7
    s_add_u32 s60, s60, s61
    v_lshlrev_b32 v195, 1, v1
    s_mov_b32 s48, s14
    s_mov_b32 s49, s15
    s_mov_b32 s50, 0x20000
    s_mov_b32 s51, 0x00020000
    buffer_load_ushort v28, v195, s[48:51], s60 offen
    s_mov_b32 s52, s16
    s_mov_b32 s53, s17
    s_mov_b32 s54, 0x20000
    s_mov_b32 s55, 0x00020000
    buffer_load_ushort v29, v195, s[52:55], s60 offen
    s_mov_b32 s48, s18
    s_mov_b32 s49, s19
    s_mov_b32 s50, 0x20000
    s_mov_b32 s51, 0x00020000
    buffer_load_ushort v30, v195, s[48:51], s60 offen
    s_mov_b32 s52, s20
    s_mov_b32 s53, s21
    s_mov_b32 s54, 0x20000
    s_mov_b32 s55, 0x00020000
    buffer_load_ushort v31, v195, s[52:55], s60 offen
    s_mov_b32 s48, s22
    s_mov_b32 s49, s23
    s_mov_b32 s50, 0x20000
    s_mov_b32 s51, 0x00020000
    buffer_load_ushort v32, v195, s[48:51], s60 offen
    s_mov_b32 s52, s24
    s_mov_b32 s53, s25
    s_mov_b32 s54, 0x20000
    s_mov_b32 s55, 0x00020000
    buffer_load_ushort v33, v195, s[52:55], s60 offen
    s_barrier
    v_lshlrev_b32 v7, 4, v1
    v_mov_b32 v52, -1
    v_mov_b32 v53, -1
    v_mov_b32 v54, -1
    v_mov_b32 v55, -1
    v_and_b32 v236, 0x30, v1
    v_and_b32 v196, 0xf0, v7
    v_lshl_add_u32 v236, v236, 8, v196
    s_lshl_b32 s72, s38, 17
    s_add_u32 s72, s72, 69376
    s_lshl_b32 s61, s37, 8
    s_sub_u32 s72, s72, s61
    s_lshl_b32 s61, s39, 15
    s_add_u32 s72, s72, s61
    s_add_u32 s73, s72, 16384
    v_and_b32 v197, 15, v1
    v_lshlrev_b32 v197, 2, v197
    s_lshl_b32 s60, s38, 8
    s_lshl_b32 s61, s37, 8
    s_add_u32 s61, s61, 4096
    v_mov_b32 v198, s60
    v_mov_b32 v199, s61
    s_mov_b32 vcc_lo, 0xffff
    s_mov_b32 vcc_hi, 0xffff
    v_cndmask_b32 v3, v199, v198, vcc
    v_add_u32 v3, v3, v197
    v_lshrrev_b32 v197, 5, v1
    v_lshl_add_u32 v3, v197, 13, v3
    s_mov_b32 exec_hi, 0
    buffer_load_dword v2, v3, s[40:43], 0 offen sc1
    s_mov_b32 exec_hi, -1
    s_mov_b32 s48, s28
    s_mov_b32 s49, s29
    s_mov_b32 s50, 0x400
    s_mov_b32 s51, 0x00020000
    v_and_b32 v196, 0x30, v1
    s_lshl_b32 s60, s38, 6
    buffer_load_dwordx4 v[16:19], v196, s[48:51], s60 offen
    v_mov_b32 v4, 160272
    s_lshl_b32 s60, s39, 2
    s_add_u32 s60, s60, 160272
    v_mov_b32 v5, s60
    v_xor_b32 v6, 4, v5
    v_and_b32 v192, 3, v1
    v_bfe_u32 v193, v1, 2, 2
    v_and_b32 v194, 0x30, v1
    s_movk_i32 s60, 4512
    v_mul_lo_u32 v195, v192, s60
    v_lshlrev_b32 v193, 7, v193
    v_sub_u32 v195, v195, v193
    v_add_u32 v195, v195, v194
    s_lshl_b32 s61, s63, 8
    s_add_u32 s61, s61, s65
    s_add_u32 s60, s61, 384
    v_add_u32 v195, s60, v195
    v_and_b32 v196, 15, v1
    v_lshl_add_u32 v196, v196, 3, v194
    s_add_u32 s60, s61, 18048
    v_add_u32 v196, s60, v196
    v_and_b32 v198, 1, v1
    v_and_b32 v197, 62, v1
    v_lshlrev_b32 v197, 3, v197
    v_lshl_add_u32 v197, v198, 9, v197
    v_xor_b32 v197, 0x300, v197
    s_xor_b32 s71, s63, 1
    s_lshl_b32 s71, s71, 11
    s_add_u32 s60, s71, s65
    v_add_u32 v198, s60, v197
    v_mov_b32 v219, v195
    v_mov_b32 v220, v196
    v_mov_b32 v221, v197
    v_mov_b32 v239, v198
    v_and_b32 v192, 15, v1
    v_bfe_u32 v193, v1, 2, 2
    v_and_b32 v194, 3, v1
    s_mul_i32 s60, s39, 4352
    s_add_u32 s60, s60, 136960
    v_lshl_add_u32 v34, v1, 2, s60
    v_add_u32 v35, 1088, v34
    v_add_u32 v36, 2176, v34
    v_add_u32 v37, 3264, v34
    v_mul_u32_u24 v38, 272, v192
    v_and_b32 v39, 0x30, v1
    v_add3_u32 v38, v38, v39, s60
    v_lshrrev_b32 v192, 4, v1
    v_lshl_add_u32 v232, v192, 3, v193
    v_sub_u32 v232, 27, v232
    v_lshlrev_b32 v232, 6, v232
    v_lshl_add_u32 v232, v194, 3, v232
    v_add_u32 v232, s68, v232
    v_and_b32 v196, 15, v1
    v_lshlrev_b32 v233, 6, v196
    v_lshl_add_u32 v233, v192, 4, v233
    v_add_u32 v233, s68, v233
    s_movk_i32 s60, 272
    v_mul_lo_u32 v234, v196, s60
    v_lshl_add_u32 v234, v192, 4, v234
    s_lshl_b32 s61, s39, 6
    s_sub_u32 s61, 123072, s61
    v_add_u32 v234, s61, v234
    v_mul_lo_u32 v235, v192, s60
    v_lshl_add_u32 v235, v196, 4, v235
    s_mul_i32 s61, s39, 2176
    s_add_u32 s61, s61, 122880
    v_add_u32 v235, s61, v235
    v_mov_b32 v237, 160300
    s_mov_b32 s77, s63
    s_setprio 3
    s_waitcnt vmcnt(8)
    ds_read_b64_tr_b16 v[240:241], v232 offset:256
    ds_read_b64_tr_b16 v[242:243], v232 offset:0
    ds_read_b64_tr_b16 v[244:245], v232 offset:288
    ds_read_b64_tr_b16 v[246:247], v232 offset:32
    ds_read_b128 v[8:11], v233 offset:0
    ds_read_b128 v[12:15], v233 offset:1024
    s_waitcnt lgkmcnt(4)
    ds_write_b128 v234, v[240:243] offset:0
    s_waitcnt lgkmcnt(3)
    ds_write_b128 v234, v[244:247] offset:4352
    v_mov_b32 v238, 1
    s_mov_b64 exec, 1
    ds_add_u32 v237, v238
    s_mov_b64 exec, -1
    s_setprio 0
    s_setprio 0
    s_waitcnt lgkmcnt(0)
    s_lshl_b32 s60, s64, 4
    s_lshr_b32 s66, s66, s60
    s_lshl_b32 s66, s66, 16
    s_mov_b32 s69, 0x3fb8aa3b
    v_mov_b32 v192, s66
    v_mul_f32 v192, s69, v192
    v_exp_f32 v192, v192
    s_nop 0
    v_cvt_pk_bf16_f32 v192, v192, v192
    v_and_b32 v192, 0xffff0000, v192
    s_waitcnt vmcnt(2)
    v_lshlrev_b32 v28, 16, v28
    v_lshlrev_b32 v29, 16, v29
    v_lshlrev_b32 v30, 16, v30
    v_lshlrev_b32 v31, 16, v31
    v_lshlrev_b32 v32, 16, v32
    v_lshlrev_b32 v33, 16, v33
    v_mul_f32 v28, v28, v192
    v_mul_f32 v29, v29, v192
    v_mul_f32 v30, v30, v192
    v_mul_f32 v31, v31, v192
    v_mul_f32 v196, s69, v28
    v_mul_f32 v197, 0.15915494, v29
    v_mul_f32 v198, v32, v30
    v_mul_f32 v113, -v32, v31
    v_fma_f32 v112, -v33, v31, v198
    v_fma_f32 v113, -v33, v30, v113
    s_mov_b32 s60, 0x41800000
    s_mov_b32 s61, 0x43800000
    v_mul_f32 v204, s60, v197
    v_mul_f32 v206, s61, v197
    v_mul_f32 v200, s60, v196
    v_mul_f32 v202, s61, v196
    v_fract_f32 v204, v204
    v_fract_f32 v205, v197
    v_fract_f32 v206, v206
    v_exp_f32 v200, v200
    v_cos_f32 v96, v204
    v_sin_f32 v97, v204
    v_exp_f32 v201, v196
    v_cos_f32 v66, v205
    v_sin_f32 v67, v205
    v_exp_f32 v202, v202
    v_cos_f32 v98, v206
    v_sin_f32 v99, v206
    v_mul_f32 v96, v96, v200
    v_mul_f32 v97, v97, v200
    v_mul_f32 v66, v66, v201
    v_mul_f32 v67, v67, v201
    v_mul_f32 v98, v98, v202
    v_mul_f32 v99, v99, v202
    s_setprio 3
    s_mov_b32 s79, 0
L_w_84:
    ds_read_b32 v24, v237 offset:0
    s_waitcnt lgkmcnt(0)
    v_readfirstlane_b32 s78, v24
    s_nop 0
    s_cmp_ge_u32 s78, 4
    s_cbranch_scc1 L_wd_85
    s_add_u32 s79, s79, 1
    s_cmp_lt_u32 s79, 200000
    s_cbranch_scc1 L_w_84
L_wd_85:
    ds_read_b128 v[240:243], v235 offset:0
    ds_read_b128 v[244:247], v235 offset:1088
    s_waitcnt lgkmcnt(1)
    buffer_store_dwordx4 v[240:243], v236, s[40:43], s72 offen sc1
    s_waitcnt lgkmcnt(0)
    buffer_store_dwordx4 v[244:247], v236, s[40:43], s73 offen sc1
    s_setprio 0
    s_setprio 3
    s_lshl_b32 s60, s38, 4
    s_add_u32 s60, s60, s37
    s_mul_i32 s60, s60, 2304
    s_add_u32 s60, s60, 6356992
    s_mul_i32 s61, s39, 576
    s_add_u32 s61, s61, s60
    s_mov_b32 exec_hi, 15
    buffer_store_dwordx4 v[52:55], v7, s[40:43], s61 offen sc1
    s_mov_b32 exec_hi, -1
    s_setprio 0
    v_cvt_pk_bf16_f32 v200, v112, v113
    v_mul_f32 v114, v112, v96
    v_mul_f32 v115, v113, v96
    v_fma_f32 v114, v113, v97, v114
    v_fma_f32 v115, -v112, v97, v115
    v_cvt_pk_bf16_f32 v201, v114, v115
    ds_write2_b32 v34, v200, v201 offset0:0 offset1:68
    v_mul_f32 v116, v114, v96
    v_mul_f32 v117, v115, v96
    v_fma_f32 v116, v115, v97, v116
    v_fma_f32 v117, -v114, v97, v117
    v_cvt_pk_bf16_f32 v202, v116, v117
    v_mul_f32 v118, v116, v96
    v_mul_f32 v119, v117, v96
    v_fma_f32 v118, v117, v97, v118
    v_fma_f32 v119, -v116, v97, v119
    v_cvt_pk_bf16_f32 v203, v118, v119
    ds_write2_b32 v34, v202, v203 offset0:136 offset1:204
    v_mul_f32 v112, v118, v96
    v_mul_f32 v113, v119, v96
    v_fma_f32 v112, v119, v97, v112
    v_fma_f32 v113, -v118, v97, v113
    v_cvt_pk_bf16_f32 v204, v112, v113
    v_mul_f32 v114, v112, v96
    v_mul_f32 v115, v113, v96
    v_fma_f32 v114, v113, v97, v114
    v_fma_f32 v115, -v112, v97, v115
    v_cvt_pk_bf16_f32 v205, v114, v115
    ds_write2_b32 v35, v204, v205 offset0:0 offset1:68
    v_mul_f32 v116, v114, v96
    v_mul_f32 v117, v115, v96
    v_fma_f32 v116, v115, v97, v116
    v_fma_f32 v117, -v114, v97, v117
    v_cvt_pk_bf16_f32 v206, v116, v117
    v_mul_f32 v118, v116, v96
    v_mul_f32 v119, v117, v96
    v_fma_f32 v118, v117, v97, v118
    v_fma_f32 v119, -v116, v97, v119
    v_cvt_pk_bf16_f32 v207, v118, v119
    ds_write2_b32 v35, v206, v207 offset0:136 offset1:204
    v_mul_f32 v112, v118, v96
    v_mul_f32 v113, v119, v96
    v_fma_f32 v112, v119, v97, v112
    v_fma_f32 v113, -v118, v97, v113
    v_cvt_pk_bf16_f32 v208, v112, v113
    v_mul_f32 v114, v112, v96
    v_mul_f32 v115, v113, v96
    v_fma_f32 v114, v113, v97, v114
    v_fma_f32 v115, -v112, v97, v115
    v_cvt_pk_bf16_f32 v209, v114, v115
    ds_write2_b32 v36, v208, v209 offset0:0 offset1:68
    v_mul_f32 v116, v114, v96
    v_mul_f32 v117, v115, v96
    v_fma_f32 v116, v115, v97, v116
    v_fma_f32 v117, -v114, v97, v117
    v_cvt_pk_bf16_f32 v210, v116, v117
    v_mul_f32 v118, v116, v96
    v_mul_f32 v119, v117, v96
    v_fma_f32 v118, v117, v97, v118
    v_fma_f32 v119, -v116, v97, v119
    v_cvt_pk_bf16_f32 v211, v118, v119
    ds_write2_b32 v36, v210, v211 offset0:136 offset1:204
    v_mul_f32 v112, v118, v96
    v_mul_f32 v113, v119, v96
    v_fma_f32 v112, v119, v97, v112
    v_fma_f32 v113, -v118, v97, v113
    v_cvt_pk_bf16_f32 v212, v112, v113
    v_mul_f32 v114, v112, v96
    v_mul_f32 v115, v113, v96
    v_fma_f32 v114, v113, v97, v114
    v_fma_f32 v115, -v112, v97, v115
    v_cvt_pk_bf16_f32 v213, v114, v115
    ds_write2_b32 v37, v212, v213 offset0:0 offset1:68
    v_mul_f32 v116, v114, v96
    v_mul_f32 v117, v115, v96
    v_fma_f32 v116, v115, v97, v116
    v_fma_f32 v117, -v114, v97, v117
    v_cvt_pk_bf16_f32 v214, v116, v117
    v_mul_f32 v118, v116, v96
    v_mul_f32 v119, v117, v96
    v_fma_f32 v118, v117, v97, v118
    v_fma_f32 v119, -v116, v97, v119
    v_cvt_pk_bf16_f32 v215, v118, v119
    ds_write2_b32 v37, v214, v215 offset0:136 offset1:204
    ds_read_b128 v[128:131], v38 offset:0
    ds_read_b128 v[132:135], v38 offset:64
    ds_read_b128 v[136:139], v38 offset:128
    ds_read_b128 v[140:143], v38 offset:192
    v_mov_b32 v200, 0x3f80
    v_cvt_pk_bf16_f32 v201, v66, v67
    ds_write2_b32 v34, v200, v201 offset0:0 offset1:68
    v_mul_f32 v68, v66, v66
    v_mul_f32 v69, v67, v66
    v_fma_f32 v68, -v67, v67, v68
    v_fma_f32 v69, v66, v67, v69
    v_cvt_pk_bf16_f32 v202, v68, v69
    v_mul_f32 v70, v68, v66
    v_mul_f32 v71, v69, v66
    v_fma_f32 v70, -v69, v67, v70
    v_fma_f32 v71, v68, v67, v71
    v_cvt_pk_bf16_f32 v203, v70, v71
    ds_write2_b32 v34, v202, v203 offset0:136 offset1:204
    v_mul_f32 v72, v68, v68
    v_mul_f32 v73, v69, v68
    v_fma_f32 v72, -v69, v69, v72
    v_fma_f32 v73, v68, v69, v73
    v_cvt_pk_bf16_f32 v204, v72, v73
    v_mul_f32 v74, v72, v66
    v_mul_f32 v75, v73, v66
    v_fma_f32 v74, -v73, v67, v74
    v_fma_f32 v75, v72, v67, v75
    v_cvt_pk_bf16_f32 v205, v74, v75
    ds_write2_b32 v35, v204, v205 offset0:0 offset1:68
    v_mul_f32 v76, v72, v68
    v_mul_f32 v77, v73, v68
    v_fma_f32 v76, -v73, v69, v76
    v_fma_f32 v77, v72, v69, v77
    v_cvt_pk_bf16_f32 v206, v76, v77
    v_mul_f32 v78, v72, v70
    v_mul_f32 v79, v73, v70
    v_fma_f32 v78, -v73, v71, v78
    v_fma_f32 v79, v72, v71, v79
    v_cvt_pk_bf16_f32 v207, v78, v79
    ds_write2_b32 v35, v206, v207 offset0:136 offset1:204
    v_mul_f32 v80, v72, v72
    v_mul_f32 v81, v73, v72
    v_fma_f32 v80, -v73, v73, v80
    v_fma_f32 v81, v72, v73, v81
    v_cvt_pk_bf16_f32 v208, v80, v81
    v_mul_f32 v82, v80, v66
    v_mul_f32 v83, v81, v66
    v_fma_f32 v82, -v81, v67, v82
    v_fma_f32 v83, v80, v67, v83
    v_cvt_pk_bf16_f32 v209, v82, v83
    ds_write2_b32 v36, v208, v209 offset0:0 offset1:68
    v_mul_f32 v84, v80, v68
    v_mul_f32 v85, v81, v68
    v_fma_f32 v84, -v81, v69, v84
    v_fma_f32 v85, v80, v69, v85
    v_cvt_pk_bf16_f32 v210, v84, v85
    v_mul_f32 v86, v80, v70
    v_mul_f32 v87, v81, v70
    v_fma_f32 v86, -v81, v71, v86
    v_fma_f32 v87, v80, v71, v87
    v_cvt_pk_bf16_f32 v211, v86, v87
    ds_write2_b32 v36, v210, v211 offset0:136 offset1:204
    v_mul_f32 v88, v80, v72
    v_mul_f32 v89, v81, v72
    v_fma_f32 v88, -v81, v73, v88
    v_fma_f32 v89, v80, v73, v89
    v_cvt_pk_bf16_f32 v212, v88, v89
    v_mul_f32 v90, v80, v74
    v_mul_f32 v91, v81, v74
    v_fma_f32 v90, -v81, v75, v90
    v_fma_f32 v91, v80, v75, v91
    v_cvt_pk_bf16_f32 v213, v90, v91
    ds_write2_b32 v37, v212, v213 offset0:0 offset1:68
    v_mul_f32 v92, v80, v76
    v_mul_f32 v93, v81, v76
    v_fma_f32 v92, -v81, v77, v92
    v_fma_f32 v93, v80, v77, v93
    v_cvt_pk_bf16_f32 v214, v92, v93
    v_mul_f32 v94, v80, v78
    v_mul_f32 v95, v81, v78
    v_fma_f32 v94, -v81, v79, v94
    v_fma_f32 v95, v80, v79, v95
    v_cvt_pk_bf16_f32 v215, v94, v95
    ds_write2_b32 v37, v214, v215 offset0:136 offset1:204
    ds_read_b128 v[144:147], v38 offset:0
    ds_read_b128 v[148:151], v38 offset:64
    ds_read_b128 v[152:155], v38 offset:128
    ds_read_b128 v[156:159], v38 offset:192
    v_mul_f32 v100, v98, v98
    v_mul_f32 v101, v99, v98
    v_fma_f32 v100, -v99, v99, v100
    v_fma_f32 v101, v98, v99, v101
    v_cvt_pk_bf16_f32 v200, v100, v101
    v_mul_f32 v120, v100, v72
    v_mul_f32 v121, v101, v72
    v_fma_f32 v120, -v101, v73, v120
    v_fma_f32 v121, v100, v73, v121
    v_cvt_pk_bf16_f32 v201, v120, v121
    ds_write2_b32 v34, v200, v201 offset0:0 offset1:68
    v_mul_f32 v122, v100, v80
    v_mul_f32 v123, v101, v80
    v_fma_f32 v122, -v101, v81, v122
    v_fma_f32 v123, v100, v81, v123
    v_cvt_pk_bf16_f32 v202, v122, v123
    v_mul_f32 v124, v100, v88
    v_mul_f32 v125, v101, v88
    v_fma_f32 v124, -v101, v89, v124
    v_fma_f32 v125, v100, v89, v125
    v_cvt_pk_bf16_f32 v203, v124, v125
    ds_write2_b32 v34, v202, v203 offset0:136 offset1:204
    v_mul_f32 v102, v100, v98
    v_mul_f32 v103, v101, v98
    v_fma_f32 v102, -v101, v99, v102
    v_fma_f32 v103, v100, v99, v103
    v_cvt_pk_bf16_f32 v204, v102, v103
    v_mul_f32 v126, v102, v72
    v_mul_f32 v127, v103, v72
    v_fma_f32 v126, -v103, v73, v126
    v_fma_f32 v127, v102, v73, v127
    v_cvt_pk_bf16_f32 v205, v126, v127
    ds_write2_b32 v35, v204, v205 offset0:0 offset1:68
    s_waitcnt lgkmcnt(6)
    v_mfma_f32_16x16x32_bf16 v[40:43], v[144:147], v[128:131], 0
    v_mul_f32 v120, v102, v80
    v_mul_f32 v121, v103, v80
    v_fma_f32 v120, -v103, v81, v120
    v_fma_f32 v121, v102, v81, v121
    v_cvt_pk_bf16_f32 v206, v120, v121
    v_mul_f32 v122, v102, v88
    v_mul_f32 v123, v103, v88
    v_fma_f32 v122, -v103, v89, v122
    v_fma_f32 v123, v102, v89, v123
    v_cvt_pk_bf16_f32 v207, v122, v123
    ds_write2_b32 v35, v206, v207 offset0:136 offset1:204
    s_waitcnt lgkmcnt(6)
    v_mfma_f32_16x16x32_bf16 v[40:43], v[148:151], v[132:135], v[40:43]
    v_mul_f32 v104, v100, v100
    v_mul_f32 v105, v101, v100
    v_fma_f32 v104, -v101, v101, v104
    v_fma_f32 v105, v100, v101, v105
    v_cvt_pk_bf16_f32 v208, v104, v105
    v_mul_f32 v124, v104, v80
    v_mul_f32 v125, v105, v80
    v_fma_f32 v124, -v105, v81, v124
    v_fma_f32 v125, v104, v81, v125
    v_cvt_pk_bf16_f32 v209, v124, v125
    ds_write2_b32 v36, v208, v209 offset0:0 offset1:68
    s_waitcnt lgkmcnt(6)
    v_mfma_f32_16x16x32_bf16 v[40:43], v[152:155], v[136:139], v[40:43]
    v_mul_f32 v106, v104, v98
    v_mul_f32 v107, v105, v98
    v_fma_f32 v106, -v105, v99, v106
    v_fma_f32 v107, v104, v99, v107
    v_cvt_pk_bf16_f32 v210, v106, v107
    v_mul_f32 v126, v106, v80
    v_mul_f32 v127, v107, v80
    v_fma_f32 v126, -v107, v81, v126
    v_fma_f32 v127, v106, v81, v127
    v_cvt_pk_bf16_f32 v211, v126, v127
    ds_write2_b32 v36, v210, v211 offset0:136 offset1:204
    s_waitcnt lgkmcnt(6)
    v_mfma_f32_16x16x32_bf16 v[40:43], v[156:159], v[140:143], v[40:43]
    v_mul_f32 v108, v104, v100
    v_mul_f32 v109, v105, v100
    v_fma_f32 v108, -v105, v101, v108
    v_fma_f32 v109, v104, v101, v109
    v_cvt_pk_bf16_f32 v212, v108, v109
    v_mul_f32 v120, v108, v80
    v_mul_f32 v121, v109, v80
    v_fma_f32 v120, -v109, v81, v120
    v_fma_f32 v121, v108, v81, v121
    v_cvt_pk_bf16_f32 v213, v120, v121
    ds_write2_b32 v37, v212, v213 offset0:0 offset1:68
    v_mul_f32 v110, v104, v102
    v_mul_f32 v111, v105, v102
    v_fma_f32 v110, -v105, v103, v110
    v_fma_f32 v111, v104, v103, v111
    v_cvt_pk_bf16_f32 v214, v110, v111
    v_mul_f32 v122, v110, v80
    v_mul_f32 v123, v111, v80
    v_fma_f32 v122, -v111, v81, v122
    v_fma_f32 v123, v110, v81, v123
    v_cvt_pk_bf16_f32 v215, v122, v123
    ds_write2_b32 v37, v214, v215 offset0:136 offset1:204
    ds_read_b128 v[176:179], v38 offset:0
    ds_read_b128 v[180:183], v38 offset:64
    ds_read_b128 v[184:187], v38 offset:128
    ds_read_b128 v[188:191], v38 offset:192
    v_mul_f32 v124, v110, v96
    v_mul_f32 v125, v111, v96
    v_fma_f32 v124, -v111, v97, v124
    v_fma_f32 v125, v110, v97, v125
    v_cvt_pk_bf16_f32 v209, v124, v125
    v_cvt_pk_bf16_f32 v200, v98, v99
    v_mul_f32 v126, v98, v68
    v_mul_f32 v127, v99, v68
    v_fma_f32 v126, -v99, v69, v126
    v_fma_f32 v127, v98, v69, v127
    v_cvt_pk_bf16_f32 v201, v126, v127
    ds_write2_b32 v34, v200, v201 offset0:0 offset1:68
    v_mul_f32 v120, v98, v72
    v_mul_f32 v121, v99, v72
    v_fma_f32 v120, -v99, v73, v120
    v_fma_f32 v121, v98, v73, v121
    v_cvt_pk_bf16_f32 v202, v120, v121
    ds_write2_b32 v34, v202, v209 offset0:136 offset1:204
    v_mul_f32 v122, v98, v76
    v_mul_f32 v123, v99, v76
    v_fma_f32 v122, -v99, v77, v122
    v_fma_f32 v123, v98, v77, v123
    v_cvt_pk_bf16_f32 v203, v122, v123
    ds_write2_b32 v35, v202, v203 offset0:0 offset1:68
    v_mul_f32 v124, v98, v80
    v_mul_f32 v125, v99, v80
    v_fma_f32 v124, -v99, v81, v124
    v_fma_f32 v125, v98, v81, v125
    v_cvt_pk_bf16_f32 v204, v124, v125
    ds_write2_b32 v35, v204, v209 offset0:136 offset1:204
    v_mul_f32 v126, v98, v84
    v_mul_f32 v127, v99, v84
    v_fma_f32 v126, -v99, v85, v126
    v_fma_f32 v127, v98, v85, v127
    v_cvt_pk_bf16_f32 v205, v126, v127
    ds_write2_b32 v36, v204, v205 offset0:0 offset1:68
    s_waitcnt lgkmcnt(8)
    v_mfma_f32_16x16x32_bf16 v[48:51], v[176:179], v[128:131], 0
    v_mul_f32 v120, v98, v88
    v_mul_f32 v121, v99, v88
    v_fma_f32 v120, -v99, v89, v120
    v_fma_f32 v121, v98, v89, v121
    v_cvt_pk_bf16_f32 v206, v120, v121
    ds_write2_b32 v36, v206, v209 offset0:136 offset1:204
    s_waitcnt lgkmcnt(8)
    v_mfma_f32_16x16x32_bf16 v[48:51], v[180:183], v[132:135], v[48:51]
    v_mul_f32 v122, v98, v92
    v_mul_f32 v123, v99, v92
    v_fma_f32 v122, -v99, v93, v122
    v_fma_f32 v123, v98, v93, v123
    v_cvt_pk_bf16_f32 v207, v122, v123
    ds_write2_b32 v37, v206, v207 offset0:0 offset1:68
    s_waitcnt lgkmcnt(8)
    v_mfma_f32_16x16x32_bf16 v[48:51], v[184:187], v[136:139], v[48:51]
    v_mul_f32 v124, v98, v96
    v_mul_f32 v125, v99, v96
    v_fma_f32 v124, -v99, v97, v124
    v_fma_f32 v125, v98, v97, v125
    v_cvt_pk_bf16_f32 v208, v124, v125
    ds_write2_b32 v37, v208, v209 offset0:136 offset1:204
    s_waitcnt lgkmcnt(8)
    v_mfma_f32_16x16x32_bf16 v[48:51], v[188:191], v[140:143], v[48:51]
    ds_read_b128 v[160:163], v38 offset:0
    ds_read_b128 v[164:167], v38 offset:64
    ds_read_b128 v[168:171], v38 offset:128
    ds_read_b128 v[172:175], v38 offset:192
    s_setprio 3
    s_waitcnt vmcnt(0)
    v_mov_b32 v228, 160288
    v_mov_b32 v229, 1
    s_mov_b64 exec, 1
    ds_add_rtn_u32 v230, v228, v229
    s_mov_b64 exec, -1
    s_lshl_b32 s74, 1, s37
    s_mov_b32 s75, 0
    v_add_u32 v231, 1, v2
    s_waitcnt lgkmcnt(0)
    v_readfirstlane_b32 s60, v230
    s_nop 0
    s_cmp_lg_u32 s60, 3
    s_cbranch_scc1 L_nopub_86
    s_mov_b64 exec, s[74:75]
    buffer_store_dword v231, v3, s[40:43], 0 offen sc1
    s_mov_b64 exec, -1
L_nopub_86:
    v_not_b32 v240, v240
    v_not_b32 v241, v241
    v_not_b32 v242, v242
    v_not_b32 v243, v243
    v_not_b32 v244, v244
    v_not_b32 v245, v245
    v_not_b32 v246, v246
    v_not_b32 v247, v247
    s_setprio 0
    s_waitcnt lgkmcnt(4)
    v_mfma_f32_16x16x32_bf16 v[44:47], v[160:163], v[128:131], 0
    s_waitcnt lgkmcnt(3)
    v_mfma_f32_16x16x32_bf16 v[44:47], v[164:167], v[132:135], v[44:47]
    s_waitcnt lgkmcnt(2)
    v_mfma_f32_16x16x32_bf16 v[44:47], v[168:171], v[136:139], v[44:47]
    s_waitcnt lgkmcnt(1)
    v_mfma_f32_16x16x32_bf16 v[44:47], v[172:175], v[140:143], v[44:47]
    s_setprio 3
    s_and_b32 s60, s37, 3
    s_lshl_b32 s60, s60, 1
    s_and_b32 s61, s38, 1
    s_add_u32 s60, s60, s61
    s_lshl_b32 s60, s60, 2
    s_add_u32 s60, s60, s39
    s_mul_i32 s60, s60, 16384
    s_lshr_b32 s61, s38, 1
    s_lshl_b32 s61, s61, 7
    s_add_u32 s60, s60, s61
    s_add_u32 s70, s10, s60
    s_addc_u32 s71, s11, 0
    s_load_dword s69, s[70:71], 0
    s_load_dword s69, s[70:71], 1024
    s_load_dword s69, s[70:71], 2048
    s_load_dword s69, s[70:71], 3072
    s_load_dword s69, s[70:71], 4096
    s_load_dword s69, s[70:71], 5120
    s_load_dword s69, s[70:71], 6144
    s_load_dword s69, s[70:71], 7168
    s_load_dword s69, s[70:71], 8192
    s_load_dword s69, s[70:71], 9216
    s_load_dword s69, s[70:71], 10240
    s_load_dword s69, s[70:71], 11264
    s_load_dword s69, s[70:71], 12288
    s_load_dword s69, s[70:71], 13312
    s_load_dword s69, s[70:71], 14336
    s_load_dword s69, s[70:71], 15360
    s_setprio 0
    s_add_u32 s60, s65, 19072
    v_add_u32 v193, s60, v7
    s_cmp_eq_u32 s63, 1
    s_cbranch_scc1 L_nh1_87
    v_mov_b32 v200, 1
    s_mov_b64 exec, 1
    ds_write_b32 v5, v200
    s_mov_b64 exec, -1
    s_mov_b32 s79, 0
L_w_89:
    ds_read_b32 v24, v6 offset:0
    s_waitcnt lgkmcnt(0)
    v_readfirstlane_b32 s78, v24
    s_nop 0
    s_cmp_ge_u32 s78, 1
    s_cbranch_scc1 L_wd_90
    s_add_u32 s79, s79, 1
    s_cmp_lt_u32 s79, 200000
    s_cbranch_scc1 L_w_89
L_wd_90:
    ds_read_b128 v[160:163], v193 offset:0
    ds_read_b128 v[164:167], v193 offset:1024
    ds_read_b128 v[168:171], v193 offset:2048
    v_and_b32 v194, 15, v1
    v_lshrrev_b32 v195, 4, v1
    s_add_u32 s60, s65, 18048
    v_lshlrev_b32 v194, 5, v194
    v_add_u32 v194, s60, v194
    v_lshl_add_u32 v196, v195, 3, v194
    v_lshl_add_u32 v197, v195, 9, v194
    v_add_u32 v197, 1140, v197
    v_lshl_add_u32 v198, v195, 10, v194
    v_add_u32 v198, 112, v198
    v_lshlrev_b32 v199, 2, v1
    v_add_u32 v199, s60, v199
    v_mov_b32 v200, 0
    s_waitcnt lgkmcnt(2)
    v_add_f32 v40, v40, v160
    v_add_f32 v41, v41, v161
    v_add_f32 v42, v42, v162
    v_add_f32 v43, v43, v163
    s_waitcnt lgkmcnt(1)
    v_add_f32 v44, v44, v164
    v_add_f32 v45, v45, v165
    v_add_f32 v46, v46, v166
    v_add_f32 v47, v47, v167
    s_waitcnt lgkmcnt(0)
    v_add_f32 v48, v48, v168
    v_add_f32 v49, v49, v169
    v_add_f32 v50, v50, v170
    v_add_f32 v51, v51, v171
    v_cvt_pk_bf16_f32 v208, v48, v48
    v_cvt_pk_bf16_f32 v209, v48, v49
    v_cvt_pk_bf16_f32 v210, v49, v49
    v_cvt_pk_bf16_f32 v211, v50, v50
    v_cvt_pk_bf16_f32 v212, v50, v51
    v_cvt_pk_bf16_f32 v213, v51, v51
    v_cvt_pk_bf16_f32 v214, v44, v44
    v_cvt_pk_bf16_f32 v215, v45, v46
    v_cvt_pk_bf16_f32 v216, v40, v41
    v_cvt_pk_bf16_f32 v217, v42, v43
    v_cvt_pk_bf16_f32 v218, v47, v47
    s_mov_b32 s70, 0
    s_mov_b32 s71, -1
    s_mov_b64 exec, s[70:71]
    ds_write2_b32 v198, v208, v208 offset0:0 offset1:1
    ds_write2_b32 v198, v208, v208 offset0:2 offset1:3
    ds_write2_b32 v198, v209, v210 offset0:4 offset1:5
    ds_write2_b32 v198, v210, v210 offset0:6 offset1:7
    ds_write2_b32 v198, v211, v211 offset0:128 offset1:129
    ds_write2_b32 v198, v211, v211 offset0:130 offset1:131
    ds_write2_b32 v198, v212, v213 offset0:132 offset1:133
    ds_write2_b32 v198, v213, v213 offset0:134 offset1:135
    s_mov_b32 exec_lo, -1
    s_mov_b32 exec_hi, 0
    ds_write2_b32 v197, v208, v208 offset0:0 offset1:1
    ds_write2_b32 v197, v209, v210 offset0:2 offset1:3
    ds_write2_b32 v197, v211, v211 offset0:4 offset1:5
    ds_write2_b32 v197, v212, v213 offset0:6 offset1:7
    s_mov_b64 exec, -1
    ds_write_b64 v196, v[214:215] offset:632
    ds_write_b64 v196, v[216:217] offset:120
    s_mov_b64 exec, 0x8000
    ds_write_b32 v194, v218 offset:3728
    ds_write_b32 v194, v218 offset:3732
    s_mov_b64 exec, 0x3fffffff
    ds_write_b32 v199, v200
    s_mov_b64 exec, -1
    v_mov_b32 v200, 2
    s_mov_b64 exec, 1
    ds_write_b32 v5, v200
    s_mov_b64 exec, -1
    v_mov_b32 v201, 160256
    s_mov_b32 s79, 0
L_w_91:
    ds_read_b128 v[24:27], v201 offset:0
    s_waitcnt lgkmcnt(0)
    v_min3_u32 v24, v24, v25, v26
    v_min_u32 v24, v24, v27
    s_nop 0
    v_readfirstlane_b32 s78, v24
    s_nop 0
    s_cmp_ge_u32 s78, 4
    s_cbranch_scc1 L_wd_92
    s_add_u32 s79, s79, 1
    s_cmp_lt_u32 s79, 200000
    s_cbranch_scc1 L_w_91
L_wd_92:
    s_lshl_b32 s60, s37, 2
    s_add_u32 s60, s60, s39
    s_lshl_b32 s60, s60, 4
    s_add_u32 s60, s60, s38
    s_lshl_b32 s60, s60, 11
    s_add_u32 s60, s60, 4259840
    s_add_u32 s61, s60, 32768
    v_mov_b32 v224, -1
    v_mov_b32 v225, -1
    v_mov_b32 v226, -1
    v_mov_b32 v227, -1
    buffer_store_dwordx4 v[224:227], v7, s[40:43], s60 offen offset:0 sc1
    buffer_store_dwordx4 v[224:227], v7, s[40:43], s60 offen offset:1024 sc1
    buffer_store_dwordx4 v[224:227], v7, s[40:43], s61 offen offset:0 sc1
    buffer_store_dwordx4 v[224:227], v7, s[40:43], s61 offen offset:1024 sc1
    s_waitcnt vmcnt(0)
    v_mov_b32 v228, 160304
    v_mov_b32 v229, 1
    s_mov_b64 exec, 1
    ds_add_rtn_u32 v230, v228, v229
    s_mov_b64 exec, -1
    s_lshl_b32 s74, 0x10000, s38
    s_mov_b32 s75, 0
    v_add_u32 v231, 1, v2
    s_waitcnt lgkmcnt(0)
    v_readfirstlane_b32 s60, v230
    s_nop 0
    s_cmp_lg_u32 s60, 1
    s_cbranch_scc1 L_nopub_93
    s_mov_b64 exec, s[74:75]
    buffer_store_dword v231, v3, s[40:43], 0 offen sc1
    s_mov_b64 exec, -1
L_nopub_93:
    s_cmp_eq_u32 s39, 0
    s_cselect_b32 s76, 1, 0
    s_cmp_eq_u32 s76, 0
    s_cbranch_scc1 L_rbs_94
    s_mov_b32 exec_lo, 0xffff0000
    s_mov_b32 exec_hi, 0
    buffer_load_dword v204, v3, s[40:43], 0 offen sc1
L_rbs_94:
    s_mov_b64 exec, -1
    s_branch L_nhj_88
L_nh1_87:
    s_nop 7
    ds_write_b128 v193, v[40:43] offset:0
    ds_write_b128 v193, v[44:47] offset:1024
    ds_write_b128 v193, v[48:51] offset:2048
    v_mov_b32 v200, 1
    s_mov_b64 exec, 1
    ds_write_b32 v5, v200
    s_mov_b64 exec, -1
    s_cmp_eq_u32 s77, 2
    s_cbranch_scc1 L_ug_99
    s_cmp_eq_u32 s39, 3
    s_cbranch_scc1 L_w3_97
    v_mov_b32 v201, 160256
    s_mov_b32 s79, 0
L_w_102:
    ds_read_b128 v[24:27], v201 offset:0
    s_waitcnt lgkmcnt(0)
    v_min3_u32 v24, v24, v25, v26
    v_min_u32 v24, v24, v27
    s_nop 0
    v_readfirstlane_b32 s78, v24
    s_nop 0
    s_cmp_ge_u32 s78, 4
    s_cbranch_scc1 L_wd_103
    s_add_u32 s79, s79, 1
    s_cmp_lt_u32 s79, 200000
    s_cbranch_scc1 L_w_102
L_wd_103:
    s_mov_b32 s61, 0
    s_mov_b64 exec, 0xffff
L_poll_100:
    buffer_load_dword v200, v3, s[40:43], 0 offen sc1
    s_waitcnt vmcnt(0)
    v_cmp_eq_u32 vcc, v200, v2
    s_nop 1
    s_cbranch_vccz L_polld_101
    s_sleep 4
    s_add_u32 s61, s61, 1
    s_cmp_lt_u32 s61, 20000
    s_cbranch_scc1 L_poll_100
L_polld_101:
    s_mov_b64 exec, 1
    v_mov_b32 v201, 160292
    v_mov_b32 v202, 1
    ds_write_b32 v201, v202
    s_mov_b64 exec, -1
    s_branch L_rdy_98
L_w3_97:
    s_mov_b32 s79, 0
L_w_104:
    ds_read_b32 v24, v4 offset:20
    s_waitcnt lgkmcnt(0)
    v_readfirstlane_b32 s78, v24
    s_nop 0
    s_cmp_ge_u32 s78, 1
    s_cbranch_scc1 L_wd_105
    s_add_u32 s79, s79, 1
    s_cmp_lt_u32 s79, 200000
    s_cbranch_scc1 L_w_104
L_wd_105:
L_rdy_98:
    s_lshl_b32 s60, s62, 12
    s_add_u32 s44, s34, s60
    s_addc_u32 s45, s35, 0
    s_add_u32 s44, s44, 65536
    s_addc_u32 s45, s45, 0
    s_mov_b32 s46, 0x1000
    s_mov_b32 s47, 0x00020000
    s_mov_b32 s60, 16
    buffer_load_dwordx4 v[64:67], v7, s[44:47], 0 offen offset:0 sc1
    buffer_load_dwordx2 v[68:69], v7, s[44:47], s60 offen offset:0 sc1
    buffer_load_dwordx4 v[72:75], v7, s[44:47], 0 offen offset:1024 sc1
    buffer_load_dwordx2 v[76:77], v7, s[44:47], s60 offen offset:1024 sc1
    buffer_load_dwordx4 v[80:83], v7, s[44:47], 0 offen offset:2048 sc1
    buffer_load_dwordx2 v[84:85], v7, s[44:47], s60 offen offset:2048 sc1
    buffer_load_dwordx4 v[88:91], v7, s[44:47], 0 offen offset:3072 sc1
    buffer_load_dwordx2 v[92:93], v7, s[44:47], s60 offen offset:3072 sc1
L_ug_99:
    v_add_u32 v194, s65, v7
    v_mov_b32 v196, 0
    v_mov_b32 v197, 0
    v_mov_b32 v198, 0
    v_mov_b32 v199, 0
    s_mov_b32 s79, 0
L_w_106:
    ds_read_b128 v[24:27], v4 offset:0
    s_waitcnt lgkmcnt(0)
    v_min3_u32 v24, v24, v25, v26
    v_min_u32 v24, v24, v27
    s_nop 0
    v_readfirstlane_b32 s78, v24
    s_nop 0
    s_cmp_ge_u32 s78, 1
    s_cbranch_scc1 L_wd_107
    s_add_u32 s79, s79, 1
    s_cmp_lt_u32 s79, 200000
    s_cbranch_scc1 L_w_106
L_wd_107:
    s_mov_b64 exec, 0xffffff
    ds_write_b128 v194, v[196:199] offset:4096
    ds_write_b128 v194, v[196:199] offset:8608
    ds_write_b128 v194, v[196:199] offset:13120
    ds_write_b128 v194, v[196:199] offset:17632
    s_mov_b64 exec, -1
    s_waitcnt vmcnt(6)
    v_alignbit_b32 v128, v65, v64, 16
    v_alignbit_b32 v129, v66, v65, 16
    v_alignbit_b32 v130, v67, v66, 16
    v_alignbit_b32 v131, v68, v67, 16
    v_alignbit_b32 v132, v69, v68, 16
    v_mov_b32 v136, v65
    v_mov_b32 v140, v129
    v_mov_b32 v137, v66
    v_mov_b32 v141, v130
    v_mov_b32 v138, v67
    v_mov_b32 v142, v131
    v_mov_b32 v139, v68
    v_mov_b32 v143, v132
    ds_write_b128 v194, v[64:67] offset:13536
    ds_write_b128 v194, v[128:131] offset:9024
    ds_write_b128 v194, v[136:139] offset:4512
    ds_write_b128 v194, v[140:143] offset:0
    s_waitcnt vmcnt(4)
    v_alignbit_b32 v144, v73, v72, 16
    v_alignbit_b32 v145, v74, v73, 16
    v_alignbit_b32 v146, v75, v74, 16
    v_alignbit_b32 v147, v76, v75, 16
    v_alignbit_b32 v148, v77, v76, 16
    v_mov_b32 v152, v73
    v_mov_b32 v156, v145
    v_mov_b32 v153, v74
    v_mov_b32 v157, v146
    v_mov_b32 v154, v75
    v_mov_b32 v158, v147
    v_mov_b32 v155, v76
    v_mov_b32 v159, v148
    ds_write_b128 v194, v[72:75] offset:14560
    ds_write_b128 v194, v[144:147] offset:10048
    ds_write_b128 v194, v[152:155] offset:5536
    ds_write_b128 v194, v[156:159] offset:1024
    s_waitcnt vmcnt(2)
    v_alignbit_b32 v128, v81, v80, 16
    v_alignbit_b32 v129, v82, v81, 16
    v_alignbit_b32 v130, v83, v82, 16
    v_alignbit_b32 v131, v84, v83, 16
    v_alignbit_b32 v132, v85, v84, 16
    v_mov_b32 v136, v81
    v_mov_b32 v140, v129
    v_mov_b32 v137, v82
    v_mov_b32 v141, v130
    v_mov_b32 v138, v83
    v_mov_b32 v142, v131
    v_mov_b32 v139, v84
    v_mov_b32 v143, v132
    ds_write_b128 v194, v[80:83] offset:15584
    ds_write_b128 v194, v[128:131] offset:11072
    ds_write_b128 v194, v[136:139] offset:6560
    ds_write_b128 v194, v[140:143] offset:2048
    s_waitcnt vmcnt(0)
    v_alignbit_b32 v144, v89, v88, 16
    v_alignbit_b32 v145, v90, v89, 16
    v_alignbit_b32 v146, v91, v90, 16
    v_alignbit_b32 v147, v92, v91, 16
    v_alignbit_b32 v148, v93, v92, 16
    v_mov_b32 v152, v89
    v_mov_b32 v156, v145
    v_mov_b32 v153, v90
    v_mov_b32 v157, v146
    v_mov_b32 v154, v91
    v_mov_b32 v158, v147
    v_mov_b32 v155, v92
    v_mov_b32 v159, v148
    ds_write_b128 v194, v[88:91] offset:16608
    ds_write_b128 v194, v[144:147] offset:12096
    ds_write_b128 v194, v[152:155] offset:7584
    ds_write_b128 v194, v[156:159] offset:3072
    v_add_u32 v203, 2, v2
    s_mov_b64 exec, s[74:75]
    buffer_store_dword v203, v3, s[40:43], 0 offen sc1
    s_mov_b64 exec, -1
    v_mov_b32 v200, 2
    s_mov_b64 exec, 1
    ds_write_b32 v5, v200
    s_mov_b64 exec, -1
    s_mov_b32 s76, 0
L_nhj_88:
    s_mov_b32 s79, 0
L_w_108:
    ds_read_b32 v24, v6 offset:0
    s_waitcnt lgkmcnt(0)
    v_readfirstlane_b32 s78, v24
    s_nop 0
    s_cmp_ge_u32 s78, 2
    s_cbranch_scc1 L_wd_109
    s_add_u32 s79, s79, 1
    s_cmp_lt_u32 s79, 200000
    s_cbranch_scc1 L_w_108
L_wd_109:
    ds_read_b128 v[64:67], v219 offset:3584
    ds_read_b64 v[128:129], v220 offset:0
    ds_read_b64 v[130:131], v220 offset:8
    ds_read_b128 v[68:71], v219 offset:3072
    ds_read_b64 v[132:133], v220 offset:512
    ds_read_b64 v[134:135], v220 offset:520
    ds_read_b128 v[72:75], v219 offset:2560
    ds_read_b64 v[136:137], v220 offset:1024
    ds_read_b64 v[138:139], v220 offset:1032
    ds_read_b128 v[76:79], v219 offset:2048
    ds_read_b64 v[140:141], v220 offset:1536
    ds_read_b64 v[142:143], v220 offset:1544
    ds_read_b128 v[80:83], v219 offset:1536
    ds_read_b64 v[144:145], v220 offset:2048
    ds_read_b64 v[146:147], v220 offset:2056
    ds_read_b128 v[84:87], v219 offset:1024
    ds_read_b64 v[148:149], v220 offset:2560
    ds_read_b64 v[150:151], v220 offset:2568
    ds_read_b128 v[88:91], v219 offset:512
    ds_read_b64 v[152:153], v220 offset:3072
    ds_read_b64 v[154:155], v220 offset:3080
    ds_read_b128 v[92:95], v219 offset:0
    ds_read_b64 v[156:157], v220 offset:3584
    ds_read_b64 v[158:159], v220 offset:3592
    s_waitcnt lgkmcnt(15)
    v_mfma_f32_16x16x32_bf16 v[32:35], v[64:67], v[128:131], 0
    s_waitcnt lgkmcnt(15)
    v_mfma_f32_16x16x32_bf16 v[36:39], v[68:71], v[128:131], 0
    s_waitcnt lgkmcnt(15)
    v_mfma_f32_16x16x32_bf16 v[40:43], v[68:71], v[132:135], 0
    v_mfma_f32_16x16x32_bf16 v[36:39], v[64:67], v[132:135], v[36:39]
    ds_read_b128 v[248:251], v239 offset:14560
    ds_read_b128 v[252:255], v239 offset:13536
    s_waitcnt lgkmcnt(15)
    v_mfma_f32_16x16x32_bf16 v[40:43], v[72:75], v[128:131], v[40:43]
    v_mfma_f32_16x16x32_bf16 v[44:47], v[72:75], v[132:135], 0
    s_waitcnt lgkmcnt(15)
    v_mfma_f32_16x16x32_bf16 v[40:43], v[64:67], v[136:139], v[40:43]
    v_mfma_f32_16x16x32_bf16 v[44:47], v[68:71], v[136:139], v[44:47]
    v_mfma_f32_16x16x32_bf16 v[48:51], v[72:75], v[136:139], 0
    s_waitcnt lgkmcnt(15)
    v_mfma_f32_16x16x32_bf16 v[44:47], v[76:79], v[128:131], v[44:47]
    v_mfma_f32_16x16x32_bf16 v[48:51], v[76:79], v[132:135], v[48:51]
    v_mfma_f32_16x16x32_bf16 v[52:55], v[76:79], v[136:139], 0
    s_waitcnt lgkmcnt(2)
    ds_read_b128 v[96:99], v219 offset:3648
    ds_read_b64 v[160:161], v220 offset:64
    ds_read_b64 v[162:163], v220 offset:72
    ds_read_b128 v[100:103], v219 offset:3136
    ds_read_b64 v[164:165], v220 offset:576
    ds_read_b64 v[166:167], v220 offset:584
    ds_read_b128 v[104:107], v219 offset:2624
    ds_read_b64 v[168:169], v220 offset:1088
    ds_read_b64 v[170:171], v220 offset:1096
    ds_read_b128 v[108:111], v219 offset:2112
    ds_read_b64 v[172:173], v220 offset:1600
    ds_read_b64 v[174:175], v220 offset:1608
    ds_read_b128 v[112:115], v219 offset:1600
    ds_read_b64 v[176:177], v220 offset:2112
    ds_read_b64 v[178:179], v220 offset:2120
    ds_read_b128 v[116:119], v219 offset:1088
    ds_read_b64 v[180:181], v220 offset:2624
    ds_read_b64 v[182:183], v220 offset:2632
    ds_read_b128 v[120:123], v219 offset:576
    ds_read_b64 v[184:185], v220 offset:3136
    ds_read_b64 v[186:187], v220 offset:3144
    ds_read_b128 v[124:127], v219 offset:64
    ds_read_b64 v[188:189], v220 offset:3648
    ds_read_b64 v[190:191], v220 offset:3656
    v_mfma_f32_16x16x32_bf16 v[44:47], v[64:67], v[140:143], v[44:47]
    v_mfma_f32_16x16x32_bf16 v[48:51], v[68:71], v[140:143], v[48:51]
    v_mfma_f32_16x16x32_bf16 v[52:55], v[72:75], v[140:143], v[52:55]
    v_mfma_f32_16x16x32_bf16 v[56:59], v[76:79], v[140:143], 0
    v_mfma_f32_16x16x32_bf16 v[48:51], v[80:83], v[128:131], v[48:51]
    v_mfma_f32_16x16x32_bf16 v[52:55], v[80:83], v[132:135], v[52:55]
    v_mfma_f32_16x16x32_bf16 v[56:59], v[80:83], v[136:139], v[56:59]
    v_mfma_f32_16x16x32_bf16 v[60:63], v[80:83], v[140:143], 0
    v_mfma_f32_16x16x32_bf16 v[48:51], v[64:67], v[144:147], v[48:51]
    v_mfma_f32_16x16x32_bf16 v[52:55], v[68:71], v[144:147], v[52:55]
    v_mfma_f32_16x16x32_bf16 v[56:59], v[72:75], v[144:147], v[56:59]
    v_mfma_f32_16x16x32_bf16 v[60:63], v[76:79], v[144:147], v[60:63]
    v_mfma_f32_16x16x32_bf16 v[52:55], v[84:87], v[128:131], v[52:55]
    v_mfma_f32_16x16x32_bf16 v[56:59], v[84:87], v[132:135], v[56:59]
    v_mfma_f32_16x16x32_bf16 v[60:63], v[84:87], v[136:139], v[60:63]
    v_mfma_f32_16x16x32_bf16 v[52:55], v[64:67], v[148:151], v[52:55]
    v_mfma_f32_16x16x32_bf16 v[56:59], v[68:71], v[148:151], v[56:59]
    v_mfma_f32_16x16x32_bf16 v[60:63], v[72:75], v[148:151], v[60:63]
    s_cmp_eq_u32 s76, 0
    s_cbranch_scc1 L_rbs_110
    s_mov_b32 exec_lo, 0xffff0000
    s_mov_b32 exec_hi, 0
    s_waitcnt vmcnt(0)
L_rbt_112:
    v_cmp_eq_u32 vcc, v204, v2
    s_nop 1
    s_cbranch_vccnz L_rbi_111
    s_mov_b32 s76, 0
    s_mov_b64 exec, s[74:75]
    v_mov_b32 v205, 160296
    v_mov_b32 v206, 1
    v_add_u32 v207, 2, v2
    ds_write_b32 v205, v206
    buffer_store_dword v207, v3, s[40:43], 0 offen sc1
    s_branch L_rbs_110
L_rbi_111:
    buffer_load_dword v204, v3, s[40:43], 0 offen sc1
L_rbs_110:
    s_mov_b64 exec, -1
    v_mfma_f32_16x16x32_bf16 v[56:59], v[88:91], v[128:131], v[56:59]
    v_mfma_f32_16x16x32_bf16 v[60:63], v[88:91], v[132:135], v[60:63]
    v_mfma_f32_16x16x32_bf16 v[56:59], v[64:67], v[152:155], v[56:59]
    v_mfma_f32_16x16x32_bf16 v[60:63], v[68:71], v[152:155], v[60:63]
    v_mfma_f32_16x16x32_bf16 v[60:63], v[64:67], v[156:159], v[60:63]
    v_mfma_f32_16x16x32_bf16 v[60:63], v[92:95], v[128:131], v[60:63]
    s_waitcnt lgkmcnt(15)
    v_mfma_f32_16x16x32_bf16 v[32:35], v[96:99], v[160:163], v[32:35]
    s_waitcnt lgkmcnt(15)
    v_mfma_f32_16x16x32_bf16 v[36:39], v[100:103], v[160:163], v[36:39]
    s_waitcnt lgkmcnt(15)
    v_mfma_f32_16x16x32_bf16 v[40:43], v[100:103], v[164:167], v[40:43]
    v_mfma_f32_16x16x32_bf16 v[36:39], v[96:99], v[164:167], v[36:39]
    s_waitcnt lgkmcnt(15)
    v_mfma_f32_16x16x32_bf16 v[40:43], v[104:107], v[160:163], v[40:43]
    v_mfma_f32_16x16x32_bf16 v[44:47], v[104:107], v[164:167], v[44:47]
    s_waitcnt lgkmcnt(15)
    v_mfma_f32_16x16x32_bf16 v[40:43], v[96:99], v[168:171], v[40:43]
    v_mfma_f32_16x16x32_bf16 v[44:47], v[100:103], v[168:171], v[44:47]
    v_mfma_f32_16x16x32_bf16 v[48:51], v[104:107], v[168:171], v[48:51]
    s_waitcnt lgkmcnt(14)
    v_mfma_f32_16x16x32_bf16 v[44:47], v[108:111], v[160:163], v[44:47]
    v_mfma_f32_16x16x32_bf16 v[48:51], v[108:111], v[164:167], v[48:51]
    v_mfma_f32_16x16x32_bf16 v[52:55], v[108:111], v[168:171], v[52:55]
    s_waitcnt lgkmcnt(0)
    ds_read_b128 v[64:67], v219 offset:3712
    ds_read_b64 v[128:129], v220 offset:128
    ds_read_b64 v[130:131], v220 offset:136
    ds_read_b128 v[68:71], v219 offset:3200
    ds_read_b64 v[132:133], v220 offset:640
    ds_read_b64 v[134:135], v220 offset:648
    ds_read_b128 v[72:75], v219 offset:2688
    ds_read_b64 v[136:137], v220 offset:1152
    ds_read_b64 v[138:139], v220 offset:1160
    ds_read_b128 v[76:79], v219 offset:2176
    ds_read_b64 v[140:141], v220 offset:1664
    ds_read_b64 v[142:143], v220 offset:1672
    ds_read_b128 v[80:83], v219 offset:1664
    ds_read_b64 v[144:145], v220 offset:2176
    ds_read_b64 v[146:147], v220 offset:2184
    ds_read_b128 v[84:87], v219 offset:1152
    ds_read_b64 v[148:149], v220 offset:2688
    ds_read_b64 v[150:151], v220 offset:2696
    ds_read_b128 v[88:91], v219 offset:640
    ds_read_b64 v[152:153], v220 offset:3200
    ds_read_b64 v[154:155], v220 offset:3208
    ds_read_b128 v[92:95], v219 offset:128
    ds_read_b64 v[156:157], v220 offset:3712
    ds_read_b64 v[158:159], v220 offset:3720
    v_mfma_f32_16x16x32_bf16 v[44:47], v[96:99], v[172:175], v[44:47]
    v_mfma_f32_16x16x32_bf16 v[48:51], v[100:103], v[172:175], v[48:51]
    v_mfma_f32_16x16x32_bf16 v[52:55], v[104:107], v[172:175], v[52:55]
    v_mfma_f32_16x16x32_bf16 v[56:59], v[108:111], v[172:175], v[56:59]
    v_mfma_f32_16x16x32_bf16 v[48:51], v[112:115], v[160:163], v[48:51]
    v_mfma_f32_16x16x32_bf16 v[52:55], v[112:115], v[164:167], v[52:55]
    v_mfma_f32_16x16x32_bf16 v[56:59], v[112:115], v[168:171], v[56:59]
    v_mfma_f32_16x16x32_bf16 v[60:63], v[112:115], v[172:175], v[60:63]
    v_mfma_f32_16x16x32_bf16 v[48:51], v[96:99], v[176:179], v[48:51]
    v_mfma_f32_16x16x32_bf16 v[52:55], v[100:103], v[176:179], v[52:55]
    v_mfma_f32_16x16x32_bf16 v[56:59], v[104:107], v[176:179], v[56:59]
    v_mfma_f32_16x16x32_bf16 v[60:63], v[108:111], v[176:179], v[60:63]
    v_mfma_f32_16x16x32_bf16 v[52:55], v[116:119], v[160:163], v[52:55]
    v_mfma_f32_16x16x32_bf16 v[56:59], v[116:119], v[164:167], v[56:59]
    v_mfma_f32_16x16x32_bf16 v[60:63], v[116:119], v[168:171], v[60:63]
    v_mfma_f32_16x16x32_bf16 v[52:55], v[96:99], v[180:183], v[52:55]
    v_mfma_f32_16x16x32_bf16 v[56:59], v[100:103], v[180:183], v[56:59]
    v_mfma_f32_16x16x32_bf16 v[60:63], v[104:107], v[180:183], v[60:63]
    s_cmp_eq_u32 s76, 0
    s_cbranch_scc1 L_rbs_113
    s_mov_b32 exec_lo, 0xffff0000
    s_mov_b32 exec_hi, 0
    s_waitcnt vmcnt(0)
L_rbt_115:
    v_cmp_eq_u32 vcc, v204, v2
    s_nop 1
    s_cbranch_vccnz L_rbi_114
    s_mov_b32 s76, 0
    s_mov_b64 exec, s[74:75]
    v_mov_b32 v205, 160296
    v_mov_b32 v206, 1
    v_add_u32 v207, 2, v2
    ds_write_b32 v205, v206
    buffer_store_dword v207, v3, s[40:43], 0 offen sc1
    s_branch L_rbs_113
L_rbi_114:
    buffer_load_dword v204, v3, s[40:43], 0 offen sc1
L_rbs_113:
    s_mov_b64 exec, -1
    v_mfma_f32_16x16x32_bf16 v[56:59], v[120:123], v[160:163], v[56:59]
    v_mfma_f32_16x16x32_bf16 v[60:63], v[120:123], v[164:167], v[60:63]
    v_mfma_f32_16x16x32_bf16 v[56:59], v[96:99], v[184:187], v[56:59]
    v_mfma_f32_16x16x32_bf16 v[60:63], v[100:103], v[184:187], v[60:63]
    v_mfma_f32_16x16x32_bf16 v[60:63], v[96:99], v[188:191], v[60:63]
    v_mfma_f32_16x16x32_bf16 v[60:63], v[124:127], v[160:163], v[60:63]
    s_waitcnt lgkmcnt(15)
    v_mfma_f32_16x16x32_bf16 v[32:35], v[64:67], v[128:131], v[32:35]
    s_waitcnt lgkmcnt(15)
    v_mfma_f32_16x16x32_bf16 v[36:39], v[68:71], v[128:131], v[36:39]
    s_waitcnt lgkmcnt(15)
    v_mfma_f32_16x16x32_bf16 v[40:43], v[68:71], v[132:135], v[40:43]
    v_mfma_f32_16x16x32_bf16 v[36:39], v[64:67], v[132:135], v[36:39]
    s_waitcnt lgkmcnt(15)
    v_mfma_f32_16x16x32_bf16 v[40:43], v[72:75], v[128:131], v[40:43]
    v_mfma_f32_16x16x32_bf16 v[44:47], v[72:75], v[132:135], v[44:47]
    s_waitcnt lgkmcnt(15)
    v_mfma_f32_16x16x32_bf16 v[40:43], v[64:67], v[136:139], v[40:43]
    v_mfma_f32_16x16x32_bf16 v[44:47], v[68:71], v[136:139], v[44:47]
    v_mfma_f32_16x16x32_bf16 v[48:51], v[72:75], v[136:139], v[48:51]
    s_waitcnt lgkmcnt(14)
    v_mfma_f32_16x16x32_bf16 v[44:47], v[76:79], v[128:131], v[44:47]
    v_mfma_f32_16x16x32_bf16 v[48:51], v[76:79], v[132:135], v[48:51]
    v_mfma_f32_16x16x32_bf16 v[52:55], v[76:79], v[136:139], v[52:55]
    s_waitcnt lgkmcnt(0)
    ds_read_b128 v[96:99], v219 offset:3776
    ds_read_b64 v[160:161], v220 offset:192
    ds_read_b64 v[162:163], v220 offset:200
    ds_read_b128 v[100:103], v219 offset:3264
    ds_read_b64 v[164:165], v220 offset:704
    ds_read_b64 v[166:167], v220 offset:712
    ds_read_b128 v[104:107], v219 offset:2752
    ds_read_b64 v[168:169], v220 offset:1216
    ds_read_b64 v[170:171], v220 offset:1224
    ds_read_b128 v[108:111], v219 offset:2240
    ds_read_b64 v[172:173], v220 offset:1728
    ds_read_b64 v[174:175], v220 offset:1736
    ds_read_b128 v[112:115], v219 offset:1728
    ds_read_b64 v[176:177], v220 offset:2240
    ds_read_b64 v[178:179], v220 offset:2248
    ds_read_b128 v[116:119], v219 offset:1216
    ds_read_b64 v[180:181], v220 offset:2752
    ds_read_b64 v[182:183], v220 offset:2760
    ds_read_b128 v[120:123], v219 offset:704
    ds_read_b64 v[184:185], v220 offset:3264
    ds_read_b64 v[186:187], v220 offset:3272
    ds_read_b128 v[124:127], v219 offset:192
    ds_read_b64 v[188:189], v220 offset:3776
    ds_read_b64 v[190:191], v220 offset:3784
    v_mfma_f32_16x16x32_bf16 v[44:47], v[64:67], v[140:143], v[44:47]
    v_mfma_f32_16x16x32_bf16 v[48:51], v[68:71], v[140:143], v[48:51]
    v_mfma_f32_16x16x32_bf16 v[52:55], v[72:75], v[140:143], v[52:55]
    v_mfma_f32_16x16x32_bf16 v[56:59], v[76:79], v[140:143], v[56:59]
    v_mfma_f32_16x16x32_bf16 v[48:51], v[80:83], v[128:131], v[48:51]
    v_mfma_f32_16x16x32_bf16 v[52:55], v[80:83], v[132:135], v[52:55]
    v_mfma_f32_16x16x32_bf16 v[56:59], v[80:83], v[136:139], v[56:59]
    v_mfma_f32_16x16x32_bf16 v[60:63], v[80:83], v[140:143], v[60:63]
    v_mfma_f32_16x16x32_bf16 v[48:51], v[64:67], v[144:147], v[48:51]
    v_mfma_f32_16x16x32_bf16 v[52:55], v[68:71], v[144:147], v[52:55]
    v_mfma_f32_16x16x32_bf16 v[56:59], v[72:75], v[144:147], v[56:59]
    v_mfma_f32_16x16x32_bf16 v[60:63], v[76:79], v[144:147], v[60:63]
    v_mfma_f32_16x16x32_bf16 v[52:55], v[84:87], v[128:131], v[52:55]
    v_mfma_f32_16x16x32_bf16 v[56:59], v[84:87], v[132:135], v[56:59]
    v_mfma_f32_16x16x32_bf16 v[60:63], v[84:87], v[136:139], v[60:63]
    v_mfma_f32_16x16x32_bf16 v[52:55], v[64:67], v[148:151], v[52:55]
    v_mfma_f32_16x16x32_bf16 v[56:59], v[68:71], v[148:151], v[56:59]
    v_mfma_f32_16x16x32_bf16 v[60:63], v[72:75], v[148:151], v[60:63]
    s_cmp_eq_u32 s76, 0
    s_cbranch_scc1 L_rbs_116
    s_mov_b32 exec_lo, 0xffff0000
    s_mov_b32 exec_hi, 0
    s_waitcnt vmcnt(0)
L_rbt_118:
    v_cmp_eq_u32 vcc, v204, v2
    s_nop 1
    s_cbranch_vccnz L_rbi_117
    s_mov_b32 s76, 0
    s_mov_b64 exec, s[74:75]
    v_mov_b32 v205, 160296
    v_mov_b32 v206, 1
    v_add_u32 v207, 2, v2
    ds_write_b32 v205, v206
    buffer_store_dword v207, v3, s[40:43], 0 offen sc1
    s_branch L_rbs_116
L_rbi_117:
    buffer_load_dword v204, v3, s[40:43], 0 offen sc1
L_rbs_116:
    s_mov_b64 exec, -1
    v_mfma_f32_16x16x32_bf16 v[56:59], v[88:91], v[128:131], v[56:59]
    v_mfma_f32_16x16x32_bf16 v[60:63], v[88:91], v[132:135], v[60:63]
    v_mfma_f32_16x16x32_bf16 v[56:59], v[64:67], v[152:155], v[56:59]
    v_mfma_f32_16x16x32_bf16 v[60:63], v[68:71], v[152:155], v[60:63]
    v_mfma_f32_16x16x32_bf16 v[60:63], v[64:67], v[156:159], v[60:63]
    v_mfma_f32_16x16x32_bf16 v[60:63], v[92:95], v[128:131], v[60:63]
    s_waitcnt lgkmcnt(15)
    v_mfma_f32_16x16x32_bf16 v[32:35], v[96:99], v[160:163], v[32:35]
    s_waitcnt lgkmcnt(15)
    v_mfma_f32_16x16x32_bf16 v[36:39], v[100:103], v[160:163], v[36:39]
    s_waitcnt lgkmcnt(15)
    v_mfma_f32_16x16x32_bf16 v[40:43], v[100:103], v[164:167], v[40:43]
    v_mfma_f32_16x16x32_bf16 v[36:39], v[96:99], v[164:167], v[36:39]
    s_waitcnt lgkmcnt(15)
    v_mfma_f32_16x16x32_bf16 v[40:43], v[104:107], v[160:163], v[40:43]
    v_mfma_f32_16x16x32_bf16 v[44:47], v[104:107], v[164:167], v[44:47]
    s_waitcnt lgkmcnt(15)
    v_mfma_f32_16x16x32_bf16 v[40:43], v[96:99], v[168:171], v[40:43]
    v_mfma_f32_16x16x32_bf16 v[44:47], v[100:103], v[168:171], v[44:47]
    v_mfma_f32_16x16x32_bf16 v[48:51], v[104:107], v[168:171], v[48:51]
    s_waitcnt lgkmcnt(14)
    v_mfma_f32_16x16x32_bf16 v[44:47], v[108:111], v[160:163], v[44:47]
    v_mfma_f32_16x16x32_bf16 v[48:51], v[108:111], v[164:167], v[48:51]
    v_mfma_f32_16x16x32_bf16 v[52:55], v[108:111], v[168:171], v[52:55]
    s_waitcnt lgkmcnt(12)
    v_mfma_f32_16x16x32_bf16 v[44:47], v[96:99], v[172:175], v[44:47]
    v_mfma_f32_16x16x32_bf16 v[48:51], v[100:103], v[172:175], v[48:51]
    v_mfma_f32_16x16x32_bf16 v[52:55], v[104:107], v[172:175], v[52:55]
    v_mfma_f32_16x16x32_bf16 v[56:59], v[108:111], v[172:175], v[56:59]
    s_waitcnt lgkmcnt(11)
    v_mfma_f32_16x16x32_bf16 v[48:51], v[112:115], v[160:163], v[48:51]
    v_mfma_f32_16x16x32_bf16 v[52:55], v[112:115], v[164:167], v[52:55]
    v_mfma_f32_16x16x32_bf16 v[56:59], v[112:115], v[168:171], v[56:59]
    v_mfma_f32_16x16x32_bf16 v[60:63], v[112:115], v[172:175], v[60:63]
    s_waitcnt lgkmcnt(9)
    v_mfma_f32_16x16x32_bf16 v[48:51], v[96:99], v[176:179], v[48:51]
    v_mfma_f32_16x16x32_bf16 v[52:55], v[100:103], v[176:179], v[52:55]
    v_mfma_f32_16x16x32_bf16 v[56:59], v[104:107], v[176:179], v[56:59]
    v_mfma_f32_16x16x32_bf16 v[60:63], v[108:111], v[176:179], v[60:63]
    s_waitcnt lgkmcnt(8)
    v_mfma_f32_16x16x32_bf16 v[52:55], v[116:119], v[160:163], v[52:55]
    v_mfma_f32_16x16x32_bf16 v[56:59], v[116:119], v[164:167], v[56:59]
    v_mfma_f32_16x16x32_bf16 v[60:63], v[116:119], v[168:171], v[60:63]
    s_waitcnt lgkmcnt(6)
    v_mfma_f32_16x16x32_bf16 v[52:55], v[96:99], v[180:183], v[52:55]
    v_mfma_f32_16x16x32_bf16 v[56:59], v[100:103], v[180:183], v[56:59]
    v_mfma_f32_16x16x32_bf16 v[60:63], v[104:107], v[180:183], v[60:63]
    s_cmp_eq_u32 s76, 0
    s_cbranch_scc1 L_rbs_119
    s_mov_b32 exec_lo, 0xffff0000
    s_mov_b32 exec_hi, 0
    s_waitcnt vmcnt(0)
L_rbt_121:
    v_cmp_eq_u32 vcc, v204, v2
    s_nop 1
    s_cbranch_vccnz L_rbi_120
    s_mov_b32 s76, 0
    s_mov_b64 exec, s[74:75]
    v_mov_b32 v205, 160296
    v_mov_b32 v206, 1
    v_add_u32 v207, 2, v2
    ds_write_b32 v205, v206
    buffer_store_dword v207, v3, s[40:43], 0 offen sc1
    s_branch L_rbs_119
L_rbi_120:
    buffer_load_dword v204, v3, s[40:43], 0 offen sc1
L_rbs_119:
    s_mov_b64 exec, -1
    s_waitcnt lgkmcnt(5)
    v_mfma_f32_16x16x32_bf16 v[56:59], v[120:123], v[160:163], v[56:59]
    v_mfma_f32_16x16x32_bf16 v[60:63], v[120:123], v[164:167], v[60:63]
    s_waitcnt lgkmcnt(3)
    v_mfma_f32_16x16x32_bf16 v[56:59], v[96:99], v[184:187], v[56:59]
    v_mfma_f32_16x16x32_bf16 v[60:63], v[100:103], v[184:187], v[60:63]
    s_waitcnt lgkmcnt(0)
    v_mfma_f32_16x16x32_bf16 v[60:63], v[96:99], v[188:191], v[60:63]
    v_mfma_f32_16x16x32_bf16 v[60:63], v[124:127], v[160:163], v[60:63]
    v_mov_b32 v200, 3
    s_mov_b64 exec, 1
    ds_write_b32 v5, v200
    s_mov_b64 exec, -1
    s_mul_i32 s60, s63, 4512
    s_add_u32 s60, s60, s65
    v_add_u32 v192, s60, v7
    s_xor_b32 s61, s63, 1
    s_mul_i32 s61, s61, 4512
    s_add_u32 s61, s61, s65
    v_add_u32 v193, s61, v7
    s_xor_b32 s66, s63, 1
    s_lshl_b32 s66, s66, 11
    s_lshl_b32 s60, s62, 12
    s_add_u32 s60, s60, s66
    s_add_u32 s60, s60, 65536
    s_mov_b32 s79, 0
L_w_122:
    ds_read_b32 v24, v6 offset:0
    s_waitcnt lgkmcnt(0)
    v_readfirstlane_b32 s78, v24
    s_nop 0
    s_cmp_ge_u32 s78, 3
    s_cbranch_scc1 L_wd_123
    s_add_u32 s79, s79, 1
    s_cmp_lt_u32 s79, 200000
    s_cbranch_scc1 L_w_122
L_wd_123:
    s_cmp_eq_u32 s63, 1
    s_cbranch_scc1 L_c1_124
    ds_write_b128 v192, v[48:51] offset:0
    ds_write_b128 v192, v[52:55] offset:1024
    ds_write_b128 v192, v[56:59] offset:2048
    ds_write_b128 v192, v[60:63] offset:3072
    v_mov_b32 v200, 4
    s_mov_b64 exec, 1
    ds_write_b32 v5, v200
    s_mov_b64 exec, -1
    s_mov_b32 s79, 0
L_w_126:
    ds_read_b32 v24, v6 offset:0
    s_waitcnt lgkmcnt(0)
    v_readfirstlane_b32 s78, v24
    s_nop 0
    s_cmp_ge_u32 s78, 4
    s_cbranch_scc1 L_wd_127
    s_add_u32 s79, s79, 1
    s_cmp_lt_u32 s79, 200000
    s_cbranch_scc1 L_w_126
L_wd_127:
    ds_read_b128 v[64:67], v193 offset:0
    ds_read_b128 v[68:71], v193 offset:1024
    ds_read_b128 v[72:75], v193 offset:2048
    ds_read_b128 v[76:79], v193 offset:3072
    s_waitcnt lgkmcnt(3)
    v_add_f32 v64, v64, v32
    v_add_f32 v65, v65, v33
    v_add_f32 v66, v66, v34
    v_add_f32 v67, v67, v35
    s_waitcnt lgkmcnt(2)
    v_add_f32 v68, v68, v36
    v_add_f32 v69, v69, v37
    v_add_f32 v70, v70, v38
    v_add_f32 v71, v71, v39
    s_waitcnt lgkmcnt(1)
    v_add_f32 v72, v72, v40
    v_add_f32 v73, v73, v41
    v_add_f32 v74, v74, v42
    v_add_f32 v75, v75, v43
    s_waitcnt lgkmcnt(0)
    v_add_f32 v76, v76, v44
    v_add_f32 v77, v77, v45
    v_add_f32 v78, v78, v46
    v_add_f32 v79, v79, v47
    s_branch L_cj_125
L_c1_124:
    ds_write_b128 v192, v[32:35] offset:0
    ds_write_b128 v192, v[36:39] offset:1024
    ds_write_b128 v192, v[40:43] offset:2048
    ds_write_b128 v192, v[44:47] offset:3072
    v_mov_b32 v200, 4
    s_mov_b64 exec, 1
    ds_write_b32 v5, v200
    s_mov_b64 exec, -1
    s_mov_b32 s79, 0
L_w_128:
    ds_read_b32 v24, v6 offset:0
    s_waitcnt lgkmcnt(0)
    v_readfirstlane_b32 s78, v24
    s_nop 0
    s_cmp_ge_u32 s78, 4
    s_cbranch_scc1 L_wd_129
    s_add_u32 s79, s79, 1
    s_cmp_lt_u32 s79, 200000
    s_cbranch_scc1 L_w_128
L_wd_129:
    ds_read_b128 v[64:67], v193 offset:0
    ds_read_b128 v[68:71], v193 offset:1024
    ds_read_b128 v[72:75], v193 offset:2048
    ds_read_b128 v[76:79], v193 offset:3072
    s_waitcnt lgkmcnt(3)
    v_add_f32 v64, v64, v48
    v_add_f32 v65, v65, v49
    v_add_f32 v66, v66, v50
    v_add_f32 v67, v67, v51
    s_waitcnt lgkmcnt(2)
    v_add_f32 v68, v68, v52
    v_add_f32 v69, v69, v53
    v_add_f32 v70, v70, v54
    v_add_f32 v71, v71, v55
    s_waitcnt lgkmcnt(1)
    v_add_f32 v72, v72, v56
    v_add_f32 v73, v73, v57
    v_add_f32 v74, v74, v58
    v_add_f32 v75, v75, v59
    s_waitcnt lgkmcnt(0)
    v_add_f32 v76, v76, v60
    v_add_f32 v77, v77, v61
    v_add_f32 v78, v78, v62
    v_add_f32 v79, v79, v63
L_cj_125:
    v_cvt_pk_bf16_f32 v96, v64, v65
    v_cvt_pk_bf16_f32 v97, v66, v67
    v_cvt_pk_bf16_f32 v98, v68, v69
    v_cvt_pk_bf16_f32 v99, v70, v71
    v_cvt_pk_bf16_f32 v100, v72, v73
    v_cvt_pk_bf16_f32 v101, v74, v75
    v_cvt_pk_bf16_f32 v102, v76, v77
    v_cvt_pk_bf16_f32 v103, v78, v79
    v_min_u32 v96, -2, v96
    v_min_u32 v97, -2, v97
    v_min_u32 v98, -2, v98
    v_min_u32 v99, -2, v99
    v_min_u32 v100, -2, v100
    v_min_u32 v101, -2, v101
    v_min_u32 v102, -2, v102
    v_min_u32 v103, -2, v103
    s_mov_b32 vcc_lo, 0x55555555
    s_mov_b32 vcc_hi, 0x55555555
    v_cndmask_b32_dpp v104, v98, v96, vcc quad_perm:[1,0,3,2] row_mask:0xf bank_mask:0xf
    v_cndmask_b32_dpp v105, v99, v97, vcc quad_perm:[1,0,3,2] row_mask:0xf bank_mask:0xf
    v_cndmask_b32_dpp v108, v102, v100, vcc quad_perm:[1,0,3,2] row_mask:0xf bank_mask:0xf
    v_cndmask_b32_dpp v109, v103, v101, vcc quad_perm:[1,0,3,2] row_mask:0xf bank_mask:0xf
    s_not_b64 vcc, vcc
    v_cndmask_b32_dpp v106, v96, v98, vcc quad_perm:[1,0,3,2] row_mask:0xf bank_mask:0xf
    v_cndmask_b32_dpp v107, v97, v99, vcc quad_perm:[1,0,3,2] row_mask:0xf bank_mask:0xf
    v_cndmask_b32_dpp v110, v100, v102, vcc quad_perm:[1,0,3,2] row_mask:0xf bank_mask:0xf
    v_cndmask_b32_dpp v111, v101, v103, vcc quad_perm:[1,0,3,2] row_mask:0xf bank_mask:0xf
    v_add3_u32 v104, v104, v248, 1
    v_add3_u32 v105, v105, v249, 1
    v_add3_u32 v106, v106, v250, 1
    v_add3_u32 v107, v107, v251, 1
    buffer_store_dwordx4 v[104:107], v221, s[40:43], s60 offen offset:1024 sc1
    v_add3_u32 v108, v108, v252, 1
    v_add3_u32 v109, v109, v253, 1
    v_add3_u32 v110, v110, v254, 1
    v_add3_u32 v111, v111, v255, 1
    buffer_store_dwordx4 v[108:111], v221, s[40:43], s60 offen offset:0 sc1
    s_cmp_eq_u32 s76, 0
    s_cbranch_scc1 L_rbs_130
    s_mov_b32 exec_lo, 0xffff0000
    s_mov_b32 exec_hi, 0
    s_waitcnt vmcnt(2)
L_rbt_132:
    v_cmp_eq_u32 vcc, v204, v2
    s_nop 1
    s_cbranch_vccnz L_rbi_131
    s_mov_b32 s76, 0
    s_mov_b64 exec, s[74:75]
    v_mov_b32 v205, 160296
    v_mov_b32 v206, 1
    v_add_u32 v207, 2, v2
    ds_write_b32 v205, v206
    buffer_store_dword v207, v3, s[40:43], 0 offen sc1
    s_branch L_rbs_130
L_rbi_131:
    buffer_load_dword v204, v3, s[40:43], 0 offen sc1
    s_waitcnt vmcnt(0)
    s_add_u32 s76, s76, 1
    s_cmp_lt_u32 s76, 20000
    s_cbranch_scc1 L_rbt_132
L_rbs_130:
    s_mov_b64 exec, -1
    v_lshrrev_b32 v192, 4, v1
    v_and_b32 v193, 15, v1
    s_movk_i32 s66, 288
    v_mul_lo_u32 v195, v192, s66
    v_lshl_add_u32 v195, v193, 4, v195
    s_mul_i32 s66, s39, 2432
    s_add_u32 s66, s66, 123712
    v_add_u32 v195, s66, v195
    s_movk_i32 s66, 2432
    v_mul_lo_u32 v196, v192, s66
    v_bfe_u32 v197, v1, 2, 2
    s_movk_i32 s66, 288
    v_mul_lo_u32 v197, v197, s66
    v_add_u32 v196, v196, v197
    v_and_b32 v197, 3, v1
    v_lshl_add_u32 v196, v197, 3, v196
    s_lshl_b32 s66, s39, 6
    s_add_u32 s66, s66, 123712
    v_add_u32 v196, s66, v196
    v_lshlrev_b32 v197, 11, v193
    v_lshl_add_u32 v197, v192, 4, v197
    s_lshl_b32 s66, s37, 18
    s_lshl_b32 s67, s39, 16
    s_add_u32 s66, s66, s67
    s_lshl_b32 s67, s38, 6
    s_add_u32 s66, s66, s67
    s_add_u32 s66, s66, 1024
    s_add_u32 s67, s66, 32768
    s_mov_b32 s56, s30
    s_mov_b32 s57, s31
    s_mov_b32 s58, 0x400000
    s_mov_b32 s59, 0x00020000
    v_lshlrev_b32 v200, 16, v8
    v_and_b32 v201, 0xffff0000, v8
    v_lshlrev_b32 v202, 16, v16
    v_and_b32 v203, 0xffff0000, v16
    v_mul_f32 v200, v200, v202
    v_mul_f32 v201, v201, v203
    v_cvt_pk_bf16_f32 v200, v200, v201
    v_lshlrev_b32 v208, 16, v200
    v_and_b32 v209, 0xffff0000, v200
    v_lshlrev_b32 v200, 16, v9
    v_and_b32 v201, 0xffff0000, v9
    v_lshlrev_b32 v202, 16, v17
    v_and_b32 v203, 0xffff0000, v17
    v_mul_f32 v200, v200, v202
    v_mul_f32 v201, v201, v203
    v_cvt_pk_bf16_f32 v200, v200, v201
    v_lshlrev_b32 v210, 16, v200
    v_and_b32 v211, 0xffff0000, v200
    v_lshlrev_b32 v200, 16, v10
    v_and_b32 v201, 0xffff0000, v10
    v_lshlrev_b32 v202, 16, v18
    v_and_b32 v203, 0xffff0000, v18
    v_mul_f32 v200, v200, v202
    v_mul_f32 v201, v201, v203
    v_cvt_pk_bf16_f32 v200, v200, v201
    v_lshlrev_b32 v212, 16, v200
    v_and_b32 v213, 0xffff0000, v200
    v_lshlrev_b32 v200, 16, v11
    v_and_b32 v201, 0xffff0000, v11
    v_lshlrev_b32 v202, 16, v19
    v_and_b32 v203, 0xffff0000, v19
    v_mul_f32 v200, v200, v202
    v_mul_f32 v201, v201, v203
    v_cvt_pk_bf16_f32 v200, v200, v201
    v_lshlrev_b32 v214, 16, v200
    v_and_b32 v215, 0xffff0000, v200
    v_lshlrev_b32 v200, 16, v12
    v_and_b32 v201, 0xffff0000, v12
    v_lshlrev_b32 v202, 16, v16
    v_and_b32 v203, 0xffff0000, v16
    v_mul_f32 v200, v200, v202
    v_mul_f32 v201, v201, v203
    v_cvt_pk_bf16_f32 v200, v200, v201
    v_lshlrev_b32 v216, 16, v200
    v_and_b32 v217, 0xffff0000, v200
    v_lshlrev_b32 v200, 16, v13
    v_and_b32 v201, 0xffff0000, v13
    v_lshlrev_b32 v202, 16, v17
    v_and_b32 v203, 0xffff0000, v17
    v_mul_f32 v200, v200, v202
    v_mul_f32 v201, v201, v203
    v_cvt_pk_bf16_f32 v200, v200, v201
    v_lshlrev_b32 v218, 16, v200
    v_and_b32 v219, 0xffff0000, v200
    v_lshlrev_b32 v200, 16, v14
    v_and_b32 v201, 0xffff0000, v14
    v_lshlrev_b32 v202, 16, v18
    v_and_b32 v203, 0xffff0000, v18
    v_mul_f32 v200, v200, v202
    v_mul_f32 v201, v201, v203
    v_cvt_pk_bf16_f32 v200, v200, v201
    v_lshlrev_b32 v220, 16, v200
    v_and_b32 v221, 0xffff0000, v200
    v_lshlrev_b32 v200, 16, v15
    v_and_b32 v201, 0xffff0000, v15
    v_lshlrev_b32 v202, 16, v19
    v_and_b32 v203, 0xffff0000, v19
    v_mul_f32 v200, v200, v202
    v_mul_f32 v201, v201, v203
    v_cvt_pk_bf16_f32 v200, v200, v201
    v_lshlrev_b32 v222, 16, v200
    v_and_b32 v223, 0xffff0000, v200
    buffer_load_dwordx4 v[64:67], v236, s[40:43], s72 offen sc1
    buffer_load_dwordx4 v[68:71], v236, s[40:43], s73 offen sc1
    s_mov_b32 s77, 0
    s_waitcnt vmcnt(1)
    v_add_u32 v64, v64, v240
    v_add_u32 v65, v65, v241
    v_add_u32 v66, v66, v242
    v_add_u32 v67, v67, v243
    v_max3_u32 v72, v64, v65, v66
    v_max_u32 v72, v72, v67
    v_cmp_eq_u32 vcc, -1, v72
    s_bitset1_b32 s77, 0
    s_nop 0
    s_cbranch_vccnz L_pgs_135
    s_bitset0_b32 s77, 0
L_pgs_135:
    s_waitcnt vmcnt(0)
    v_add_u32 v68, v68, v244
    v_add_u32 v69, v69, v245
    v_add_u32 v70, v70, v246
    v_add_u32 v71, v71, v247
    v_max3_u32 v72, v68, v69, v70
    v_max_u32 v72, v72, v71
    v_cmp_eq_u32 vcc, -1, v72
    s_bitset1_b32 s77, 1
    s_nop 0
    s_cbranch_vccnz L_pgs_136
    s_bitset0_b32 s77, 1
L_pgs_136:
    s_cmp_eq_u32 s77, 0
    s_cbranch_scc0 L_pge_137
L_pgd_133:
    s_nop 7
    s_mov_b32 s79, 0
L_w_142:
    ds_read_b64 v[24:25], v4 offset:0
    s_waitcnt lgkmcnt(0)
    v_min_u32 v24, v24, v25
    s_nop 0
    v_readfirstlane_b32 s78, v24
    s_nop 0
    s_cmp_ge_u32 s78, 3
    s_cbranch_scc1 L_wd_143
    s_add_u32 s79, s79, 1
    s_cmp_lt_u32 s79, 200000
    s_cbranch_scc1 L_w_142
L_wd_143:
    ds_write_b128 v195, v[64:67] offset:0
    ds_write_b128 v195, v[68:71] offset:1152
    v_mov_b32 v200, 5
    s_mov_b64 exec, 1
    ds_write_b32 v5, v200
    s_mov_b64 exec, -1
    s_mov_b32 s79, 0
L_w_144:
    ds_read_b128 v[24:27], v4 offset:0
    s_waitcnt lgkmcnt(0)
    v_min3_u32 v24, v24, v25, v26
    v_min_u32 v24, v24, v27
    s_nop 0
    v_readfirstlane_b32 s78, v24
    s_nop 0
    s_cmp_ge_u32 s78, 5
    s_cbranch_scc1 L_wd_145
    s_add_u32 s79, s79, 1
    s_cmp_lt_u32 s79, 200000
    s_cbranch_scc1 L_w_144
L_wd_145:
    ds_read_b64_tr_b16 v[80:81], v196 offset:0
    ds_read_b64_tr_b16 v[82:83], v196 offset:1152
    ds_read_b64_tr_b16 v[84:85], v196 offset:32
    ds_read_b64_tr_b16 v[86:87], v196 offset:1184
    s_waitcnt lgkmcnt(2)
    v_lshlrev_b32 v200, 16, v80
    v_and_b32 v201, 0xffff0000, v80
    v_add_f32 v200, v200, v208
    v_add_f32 v201, v201, v209
    v_cvt_pk_bf16_f32 v96, v200, v201
    v_lshlrev_b32 v200, 16, v81
    v_and_b32 v201, 0xffff0000, v81
    v_add_f32 v200, v200, v210
    v_add_f32 v201, v201, v211
    v_cvt_pk_bf16_f32 v97, v200, v201
    v_lshlrev_b32 v200, 16, v82
    v_and_b32 v201, 0xffff0000, v82
    v_add_f32 v200, v200, v212
    v_add_f32 v201, v201, v213
    v_cvt_pk_bf16_f32 v98, v200, v201
    v_lshlrev_b32 v200, 16, v83
    v_and_b32 v201, 0xffff0000, v83
    v_add_f32 v200, v200, v214
    v_add_f32 v201, v201, v215
    v_cvt_pk_bf16_f32 v99, v200, v201
    buffer_store_dwordx4 v[96:99], v197, s[56:59], s66 offen
    s_waitcnt lgkmcnt(0)
    v_lshlrev_b32 v200, 16, v84
    v_and_b32 v201, 0xffff0000, v84
    v_add_f32 v200, v200, v216
    v_add_f32 v201, v201, v217
    v_cvt_pk_bf16_f32 v100, v200, v201
    v_lshlrev_b32 v200, 16, v85
    v_and_b32 v201, 0xffff0000, v85
    v_add_f32 v200, v200, v218
    v_add_f32 v201, v201, v219
    v_cvt_pk_bf16_f32 v101, v200, v201
    v_lshlrev_b32 v200, 16, v86
    v_and_b32 v201, 0xffff0000, v86
    v_add_f32 v200, v200, v220
    v_add_f32 v201, v201, v221
    v_cvt_pk_bf16_f32 v102, v200, v201
    v_lshlrev_b32 v200, 16, v87
    v_and_b32 v201, 0xffff0000, v87
    v_add_f32 v200, v200, v222
    v_add_f32 v201, v201, v223
    v_cvt_pk_bf16_f32 v103, v200, v201
    buffer_store_dwordx4 v[100:103], v197, s[56:59], s67 offen
    s_waitcnt vmcnt(0)
    s_endpgm
L_pge_28:
    s_mov_b32 s76, 0
L_pgl_18:
    s_sleep 4
    s_bitcmp1_b32 s77, 0
    s_cbranch_scc0 L_pgr_29
    s_add_u32 s68, s60, 0
    buffer_load_dwordx4 v[128:131], v13, s[40:43], s68 offen sc1
L_pgr_29:
    s_bitcmp1_b32 s77, 1
    s_cbranch_scc0 L_pgr_30
    s_add_u32 s68, s60, 4608
    buffer_load_dwordx4 v[132:135], v13, s[40:43], s68 offen sc1
L_pgr_30:
    s_bitcmp1_b32 s77, 2
    s_cbranch_scc0 L_pgr_31
    s_add_u32 s68, s60, 9216
    buffer_load_dwordx4 v[136:139], v13, s[40:43], s68 offen sc1
L_pgr_31:
    s_bitcmp1_b32 s77, 3
    s_cbranch_scc0 L_pgr_32
    s_add_u32 s68, s60, 13824
    buffer_load_dwordx4 v[140:143], v13, s[40:43], s68 offen sc1
L_pgr_32:
    s_bitcmp1_b32 s77, 4
    s_cbranch_scc0 L_pgr_33
    s_add_u32 s68, s60, 18432
    buffer_load_dwordx4 v[144:147], v13, s[40:43], s68 offen sc1
L_pgr_33:
    s_bitcmp1_b32 s77, 5
    s_cbranch_scc0 L_pgr_34
    s_add_u32 s68, s60, 23040
    buffer_load_dwordx4 v[148:151], v13, s[40:43], s68 offen sc1
L_pgr_34:
    s_bitcmp1_b32 s77, 6
    s_cbranch_scc0 L_pgr_35
    s_add_u32 s68, s60, 27648
    buffer_load_dwordx4 v[152:155], v13, s[40:43], s68 offen sc1
L_pgr_35:
    s_bitcmp1_b32 s77, 7
    s_cbranch_scc0 L_pgr_36
    s_add_u32 s68, s60, 32256
    buffer_load_dwordx4 v[156:159], v13, s[40:43], s68 offen sc1
L_pgr_36:
    s_bitcmp1_b32 s77, 8
    s_cbranch_scc0 L_pgr_37
    buffer_load_dwordx4 v[160:163], v15, s[40:43], s60 offen sc1
L_pgr_37:
    s_waitcnt vmcnt(0)
    s_bitcmp1_b32 s77, 0
    s_cbranch_scc0 L_pgc_38
    v_max3_u32 v24, v128, v129, v130
    v_max_u32 v24, v24, v131
    v_cmp_eq_u32 vcc, -1, v24
    s_nop 1
    s_cbranch_vccnz L_pgc_38
    s_bitset0_b32 s77, 0
    v_mfma_f32_16x16x32_bf16 v[108:111], v[104:107], v[128:131], v[108:111]
L_pgc_38:
    s_bitcmp1_b32 s77, 1
    s_cbranch_scc0 L_pgc_39
    v_max3_u32 v24, v132, v133, v134
    v_max_u32 v24, v24, v135
    v_cmp_eq_u32 vcc, -1, v24
    s_nop 1
    s_cbranch_vccnz L_pgc_39
    s_bitset0_b32 s77, 1
    v_mfma_f32_16x16x32_bf16 v[108:111], v[104:107], v[132:135], v[108:111]
L_pgc_39:
    s_bitcmp1_b32 s77, 2
    s_cbranch_scc0 L_pgc_40
    v_max3_u32 v24, v136, v137, v138
    v_max_u32 v24, v24, v139
    v_cmp_eq_u32 vcc, -1, v24
    s_nop 1
    s_cbranch_vccnz L_pgc_40
    s_bitset0_b32 s77, 2
    v_mfma_f32_16x16x32_bf16 v[108:111], v[104:107], v[136:139], v[108:111]
L_pgc_40:
    s_bitcmp1_b32 s77, 3
    s_cbranch_scc0 L_pgc_41
    v_max3_u32 v24, v140, v141, v142
    v_max_u32 v24, v24, v143
    v_cmp_eq_u32 vcc, -1, v24
    s_nop 1
    s_cbranch_vccnz L_pgc_41
    s_bitset0_b32 s77, 3
    v_mfma_f32_16x16x32_bf16 v[108:111], v[104:107], v[140:143], v[108:111]
L_pgc_41:
    s_bitcmp1_b32 s77, 4
    s_cbranch_scc0 L_pgc_42
    v_max3_u32 v24, v144, v145, v146
    v_max_u32 v24, v24, v147
    v_cmp_eq_u32 vcc, -1, v24
    s_nop 1
    s_cbranch_vccnz L_pgc_42
    s_bitset0_b32 s77, 4
    v_mfma_f32_16x16x32_bf16 v[108:111], v[104:107], v[144:147], v[108:111]
L_pgc_42:
    s_bitcmp1_b32 s77, 5
    s_cbranch_scc0 L_pgc_43
    v_max3_u32 v24, v148, v149, v150
    v_max_u32 v24, v24, v151
    v_cmp_eq_u32 vcc, -1, v24
    s_nop 1
    s_cbranch_vccnz L_pgc_43
    s_bitset0_b32 s77, 5
    v_mfma_f32_16x16x32_bf16 v[108:111], v[104:107], v[148:151], v[108:111]
L_pgc_43:
    s_bitcmp1_b32 s77, 6
    s_cbranch_scc0 L_pgc_44
    v_max3_u32 v24, v152, v153, v154
    v_max_u32 v24, v24, v155
    v_cmp_eq_u32 vcc, -1, v24
    s_nop 1
    s_cbranch_vccnz L_pgc_44
    s_bitset0_b32 s77, 6
    v_mfma_f32_16x16x32_bf16 v[108:111], v[104:107], v[152:155], v[108:111]
L_pgc_44:
    s_bitcmp1_b32 s77, 7
    s_cbranch_scc0 L_pgc_45
    v_max3_u32 v24, v156, v157, v158
    v_max_u32 v24, v24, v159
    v_cmp_eq_u32 vcc, -1, v24
    s_nop 1
    s_cbranch_vccnz L_pgc_45
    s_bitset0_b32 s77, 7
    v_mfma_f32_16x16x32_bf16 v[108:111], v[104:107], v[156:159], v[108:111]
L_pgc_45:
    s_bitcmp1_b32 s77, 8
    s_cbranch_scc0 L_pgc_46
    v_max3_u32 v24, v160, v161, v162
    v_max_u32 v24, v24, v163
    v_cmp_eq_u32 vcc, -1, v24
    s_nop 1
    s_cbranch_vccnz L_pgc_46
    s_bitset0_b32 s77, 8
L_pgc_46:
    s_cmp_eq_u32 s77, 0
    s_cbranch_scc1 L_pgd_17
    s_add_u32 s76, s76, 1
    s_cmp_lt_u32 s76, 20000
    s_cbranch_scc1 L_pgl_18
    s_branch L_pgd_17
L_pge_61:
    s_mov_b32 s76, 0
L_pgl_52:
    s_sleep 4
    s_bitcmp1_b32 s77, 0
    s_cbranch_scc0 L_pgr_62
    s_add_u32 s68, s60, 0
    buffer_load_dwordx4 v[32:35], v15, s[40:43], s68 offen offset:0 sc1
    buffer_load_dwordx4 v[36:39], v15, s[40:43], s68 offen offset:1024 sc1
L_pgr_62:
    s_bitcmp1_b32 s77, 1
    s_cbranch_scc0 L_pgr_63
    s_add_u32 s68, s60, 0
    buffer_load_dwordx4 v[40:43], v15, s[40:43], s68 offen offset:2048 sc1
    buffer_load_dwordx4 v[44:47], v15, s[40:43], s68 offen offset:3072 sc1
L_pgr_63:
    s_bitcmp1_b32 s77, 2
    s_cbranch_scc0 L_pgr_64
    s_add_u32 s68, s60, 4096
    buffer_load_dwordx4 v[48:51], v15, s[40:43], s68 offen offset:0 sc1
    buffer_load_dwordx4 v[52:55], v15, s[40:43], s68 offen offset:1024 sc1
L_pgr_64:
    s_bitcmp1_b32 s77, 3
    s_cbranch_scc0 L_pgr_65
    s_add_u32 s68, s60, 4096
    buffer_load_dwordx4 v[56:59], v15, s[40:43], s68 offen offset:2048 sc1
    buffer_load_dwordx4 v[60:63], v15, s[40:43], s68 offen offset:3072 sc1
L_pgr_65:
    s_bitcmp1_b32 s77, 4
    s_cbranch_scc0 L_pgr_66
    s_add_u32 s68, s60, 8192
    buffer_load_dwordx4 v[64:67], v15, s[40:43], s68 offen offset:0 sc1
    buffer_load_dwordx4 v[68:71], v15, s[40:43], s68 offen offset:1024 sc1
L_pgr_66:
    s_bitcmp1_b32 s77, 5
    s_cbranch_scc0 L_pgr_67
    s_add_u32 s68, s60, 8192
    buffer_load_dwordx4 v[72:75], v15, s[40:43], s68 offen offset:2048 sc1
    buffer_load_dwordx4 v[76:79], v15, s[40:43], s68 offen offset:3072 sc1
L_pgr_67:
    s_bitcmp1_b32 s77, 6
    s_cbranch_scc0 L_pgr_68
    s_add_u32 s68, s60, 12288
    buffer_load_dwordx4 v[80:83], v15, s[40:43], s68 offen offset:0 sc1
    buffer_load_dwordx4 v[84:87], v15, s[40:43], s68 offen offset:1024 sc1
L_pgr_68:
    s_bitcmp1_b32 s77, 7
    s_cbranch_scc0 L_pgr_69
    s_add_u32 s68, s60, 12288
    buffer_load_dwordx4 v[88:91], v15, s[40:43], s68 offen offset:2048 sc1
    buffer_load_dwordx4 v[92:95], v15, s[40:43], s68 offen offset:3072 sc1
L_pgr_69:
    s_waitcnt vmcnt(0)
    s_bitcmp1_b32 s77, 0
    s_cbranch_scc0 L_pgc_70
    v_max3_u32 v24, v32, v33, v34
    v_max3_u32 v24, v24, v35, v36
    v_max3_u32 v24, v24, v37, v38
    v_max_u32 v24, v24, v39
    v_cmp_eq_u32 vcc, -1, v24
    s_nop 1
    s_cbranch_vccnz L_pgc_70
    s_bitset0_b32 s77, 0
    v_mfma_f32_32x32x16_bf16 v[96:111], v[128:131], v[32:35], v[96:111]
    v_mfma_f32_32x32x16_bf16 v[112:127], v[132:135], v[32:35], v[112:127]
    v_mfma_f32_32x32x16_bf16 v[96:111], v[136:139], v[36:39], v[96:111]
    v_mfma_f32_32x32x16_bf16 v[112:127], v[140:143], v[36:39], v[112:127]
L_pgc_70:
    s_bitcmp1_b32 s77, 1
    s_cbranch_scc0 L_pgc_71
    v_max3_u32 v24, v40, v41, v42
    v_max3_u32 v24, v24, v43, v44
    v_max3_u32 v24, v24, v45, v46
    v_max_u32 v24, v24, v47
    v_cmp_eq_u32 vcc, -1, v24
    s_nop 1
    s_cbranch_vccnz L_pgc_71
    s_bitset0_b32 s77, 1
    v_mfma_f32_32x32x16_bf16 v[96:111], v[144:147], v[40:43], v[96:111]
    v_mfma_f32_32x32x16_bf16 v[112:127], v[148:151], v[40:43], v[112:127]
    v_mfma_f32_32x32x16_bf16 v[96:111], v[152:155], v[44:47], v[96:111]
    v_mfma_f32_32x32x16_bf16 v[112:127], v[156:159], v[44:47], v[112:127]
L_pgc_71:
    s_bitcmp1_b32 s77, 2
    s_cbranch_scc0 L_pgc_72
    v_max3_u32 v24, v48, v49, v50
    v_max3_u32 v24, v24, v51, v52
    v_max3_u32 v24, v24, v53, v54
    v_max_u32 v24, v24, v55
    v_cmp_eq_u32 vcc, -1, v24
    s_nop 1
    s_cbranch_vccnz L_pgc_72
    s_bitset0_b32 s77, 2
    v_mfma_f32_32x32x16_bf16 v[96:111], v[160:163], v[48:51], v[96:111]
    v_mfma_f32_32x32x16_bf16 v[112:127], v[164:167], v[48:51], v[112:127]
    v_mfma_f32_32x32x16_bf16 v[96:111], v[168:171], v[52:55], v[96:111]
    v_mfma_f32_32x32x16_bf16 v[112:127], v[172:175], v[52:55], v[112:127]
L_pgc_72:
    s_bitcmp1_b32 s77, 3
    s_cbranch_scc0 L_pgc_73
    v_max3_u32 v24, v56, v57, v58
    v_max3_u32 v24, v24, v59, v60
    v_max3_u32 v24, v24, v61, v62
    v_max_u32 v24, v24, v63
    v_cmp_eq_u32 vcc, -1, v24
    s_nop 1
    s_cbranch_vccnz L_pgc_73
    s_bitset0_b32 s77, 3
    v_mfma_f32_32x32x16_bf16 v[96:111], v[176:179], v[56:59], v[96:111]
    v_mfma_f32_32x32x16_bf16 v[112:127], v[180:183], v[56:59], v[112:127]
    v_mfma_f32_32x32x16_bf16 v[96:111], v[184:187], v[60:63], v[96:111]
    v_mfma_f32_32x32x16_bf16 v[112:127], v[188:191], v[60:63], v[112:127]
L_pgc_73:
    s_bitcmp1_b32 s77, 4
    s_cbranch_scc0 L_pgc_74
    v_max3_u32 v24, v64, v65, v66
    v_max3_u32 v24, v24, v67, v68
    v_max3_u32 v24, v24, v69, v70
    v_max_u32 v24, v24, v71
    v_cmp_eq_u32 vcc, -1, v24
    s_nop 1
    s_cbranch_vccnz L_pgc_74
    s_bitset0_b32 s77, 4
    v_mfma_f32_32x32x16_bf16 v[96:111], v[192:195], v[64:67], v[96:111]
    v_mfma_f32_32x32x16_bf16 v[112:127], v[196:199], v[64:67], v[112:127]
    v_mfma_f32_32x32x16_bf16 v[96:111], v[200:203], v[68:71], v[96:111]
    v_mfma_f32_32x32x16_bf16 v[112:127], v[204:207], v[68:71], v[112:127]
L_pgc_74:
    s_bitcmp1_b32 s77, 5
    s_cbranch_scc0 L_pgc_75
    v_max3_u32 v24, v72, v73, v74
    v_max3_u32 v24, v24, v75, v76
    v_max3_u32 v24, v24, v77, v78
    v_max_u32 v24, v24, v79
    v_cmp_eq_u32 vcc, -1, v24
    s_nop 1
    s_cbranch_vccnz L_pgc_75
    s_bitset0_b32 s77, 5
    v_mfma_f32_32x32x16_bf16 v[96:111], v[208:211], v[72:75], v[96:111]
    v_mfma_f32_32x32x16_bf16 v[112:127], v[212:215], v[72:75], v[112:127]
    v_mfma_f32_32x32x16_bf16 v[96:111], v[216:219], v[76:79], v[96:111]
    v_mfma_f32_32x32x16_bf16 v[112:127], v[220:223], v[76:79], v[112:127]
L_pgc_75:
    s_bitcmp1_b32 s77, 6
    s_cbranch_scc0 L_pgc_76
    v_max3_u32 v24, v80, v81, v82
    v_max3_u32 v24, v24, v83, v84
    v_max3_u32 v24, v24, v85, v86
    v_max_u32 v24, v24, v87
    v_cmp_eq_u32 vcc, -1, v24
    s_nop 1
    s_cbranch_vccnz L_pgc_76
    s_bitset0_b32 s77, 6
    v_mfma_f32_32x32x16_bf16 v[96:111], v[224:227], v[80:83], v[96:111]
    v_mfma_f32_32x32x16_bf16 v[112:127], v[228:231], v[80:83], v[112:127]
    v_mfma_f32_32x32x16_bf16 v[96:111], v[232:235], v[84:87], v[96:111]
    v_mfma_f32_32x32x16_bf16 v[112:127], v[236:239], v[84:87], v[112:127]
L_pgc_76:
    s_bitcmp1_b32 s77, 7
    s_cbranch_scc0 L_pgc_77
    v_max3_u32 v24, v88, v89, v90
    v_max3_u32 v24, v24, v91, v92
    v_max3_u32 v24, v24, v93, v94
    v_max_u32 v24, v24, v95
    v_cmp_eq_u32 vcc, -1, v24
    s_nop 1
    s_cbranch_vccnz L_pgc_77
    s_bitset0_b32 s77, 7
    v_mfma_f32_32x32x16_bf16 v[96:111], v[240:243], v[88:91], v[96:111]
    v_mfma_f32_32x32x16_bf16 v[112:127], v[244:247], v[88:91], v[112:127]
    v_mfma_f32_32x32x16_bf16 v[96:111], v[248:251], v[92:95], v[96:111]
    v_mfma_f32_32x32x16_bf16 v[112:127], v[252:255], v[92:95], v[112:127]
L_pgc_77:
    s_cmp_eq_u32 s77, 0
    s_cbranch_scc1 L_pgd_51
    s_add_u32 s76, s76, 1
    s_cmp_lt_u32 s76, 20000
    s_cbranch_scc1 L_pgl_52
    s_branch L_pgd_51
L_pge_137:
    s_mov_b32 s76, 0
L_pgl_134:
    s_sleep 4
    s_bitcmp1_b32 s77, 0
    s_cbranch_scc0 L_pgr_138
    buffer_load_dwordx4 v[64:67], v236, s[40:43], s72 offen sc1
L_pgr_138:
    s_bitcmp1_b32 s77, 1
    s_cbranch_scc0 L_pgr_139
    buffer_load_dwordx4 v[68:71], v236, s[40:43], s73 offen sc1
L_pgr_139:
    s_waitcnt vmcnt(0)
    s_bitcmp1_b32 s77, 0
    s_cbranch_scc0 L_pgc_140
    v_add_u32 v64, v64, v240
    v_add_u32 v65, v65, v241
    v_add_u32 v66, v66, v242
    v_add_u32 v67, v67, v243
    v_max3_u32 v72, v64, v65, v66
    v_max_u32 v72, v72, v67
    v_cmp_eq_u32 vcc, -1, v72
    s_nop 1
    s_cbranch_vccnz L_pgc_140
    s_bitset0_b32 s77, 0
L_pgc_140:
    s_bitcmp1_b32 s77, 1
    s_cbranch_scc0 L_pgc_141
    v_add_u32 v68, v68, v244
    v_add_u32 v69, v69, v245
    v_add_u32 v70, v70, v246
    v_add_u32 v71, v71, v247
    v_max3_u32 v72, v68, v69, v70
    v_max_u32 v72, v72, v71
    v_cmp_eq_u32 vcc, -1, v72
    s_nop 1
    s_cbranch_vccnz L_pgc_141
    s_bitset0_b32 s77, 1
L_pgc_141:
    s_cmp_eq_u32 s77, 0
    s_cbranch_scc1 L_pgd_133
    s_add_u32 s76, s76, 1
    s_cmp_lt_u32 s76, 20000
    s_cbranch_scc1 L_pgl_134
    s_branch L_pgd_133
L_end:
    s_endpgm
.section .rodata,"a"
.p2align 6
.amdhsa_kernel concat_heads__linear_kernel_hedgehog__ssm_conv_s4__prompt_kernel
  .amdhsa_next_free_vgpr 256
  .amdhsa_next_free_sgpr 102
  .amdhsa_accum_offset 256
  .amdhsa_group_segment_fixed_size 0
  .amdhsa_kernarg_size 128
  .amdhsa_user_sgpr_count 2
  .amdhsa_user_sgpr_kernarg_segment_ptr 1
  .amdhsa_system_sgpr_workgroup_id_x 1
.end_amdhsa_kernel
```
